```python
import torch

def _softmax(x, axis=-1):
    return torch.softmax(x, dim=axis)
def _gelu(x):
    return torch.nn.functional.gelu(x, approximate="tanh")
def _silu(x):
    return torch.nn.functional.silu(x)
def _sigmoid(x):
    return torch.sigmoid(x)
def _layernorm(x, axis=-1, eps=1e-5):
    m = x.mean(dim=axis, keepdim=True)
    v = x.var(dim=axis, keepdim=True, unbiased=False)
    return (x - m) / torch.sqrt(v + eps)
def _scatter_add(tgt, idx, src, axis=0):
    return tgt.clone().index_add_(axis, idx, src)
def _segment_sum(src, seg, n):
    out = torch.zeros((n,) + src.shape[1:], dtype=src.dtype)
    return out.index_add_(0, seg, src)
def _pad(x, pw):
    flat = tuple(v for pair in reversed(pw) for v in pair)
    return torch.nn.functional.pad(x, flat)

kernel_name = 'standalone__glu_gated_geglu__prompt'

def setup_inputs():

    _w = (lambda a: (lambda t: t.to(torch.bfloat16) if t.is_floating_point() else t)(torch.as_tensor(a)))
    B, S, Dm, Df = 1, 2048, 512, 1376
    return {
        "x": _w((lambda *s: torch.randn(*s, dtype=torch.bfloat16) * 0.05)(B, S, Dm)),
        "w_gate": _w((lambda *s: torch.randn(*s, dtype=torch.bfloat16) * 0.05)(Dm, Df) * (Dm ** -0.5)),
        "w_up": _w((lambda *s: torch.randn(*s, dtype=torch.bfloat16) * 0.05)(Dm, Df) * (Dm ** -0.5)),
        "w_down": _w((lambda *s: torch.randn(*s, dtype=torch.bfloat16) * 0.05)(Df, Dm) * (Df ** -0.5)),
    }

def reference(x, w_gate, w_up, w_down):
    g = torch.einsum("bsd,df->bsf", x, w_gate)
    u = torch.einsum("bsd,df->bsf", x, w_up)
    h = _gelu(g) * u
    return torch.einsum("bsf,fd->bsd", h, w_down)
```

```asm
; @launch grid=(256,1,1) block=(512,1,1) lds=163840
.amdgcn_target "amdgcn-amd-amdhsa--gfx950"
.text
.globl standalone__glu_gated_geglu__prompt_kernel
.p2align 8
.type standalone__glu_gated_geglu__prompt_kernel,@function
standalone__glu_gated_geglu__prompt_kernel:
KSTART:
s_load_dwordx8 s[4:11], s[0:1], 0
s_load_dwordx4 s[12:15], s[0:1], 32
s_load_dwordx2 s[16:17], s[0:1], 48
v_lshrrev_b32 v1, 6, v0
s_cmp_ge_u32 s2, 256
v_readfirstlane_b32 s75, v1
s_cbranch_scc0 GO
s_endpgm
GO:
s_xor_b32 s75, s75, 4
s_and_b32 s44, s75, 3
v_and_b32 v2, 63, v0
s_and_b32 s48, s2, 7
s_lshr_b32 s49, s2, 3
s_and_b32 s50, s49, 1
s_lshl_b32 s45, s48, 1
s_add_u32 s45, s45, s50
s_lshr_b32 s46, s49, 1
s_add_u32 s73, s46, s48
s_lshl_b32 s64, s48, 2
s_and_b32 s62, s49, 3
s_add_u32 s64, s64, s62
s_lshr_b32 s65, s49, 2
s_lshr_b32 s66, s44, 1
s_and_b32 s67, s44, 1
s_lshr_b32 s81, s48, 1
s_cmp_lt_u32 s75, 4
s_cbranch_scc1 COMPUTE
s_setprio 3
s_lshl_b32 s73, s73, 2
s_lshl_b32 s48, s45, 7
s_lshl_b32 s49, s44, 5
s_add_u32 s48, s48, s49
v_lshrrev_b32 v3, 3, v2
v_lshlrev_b32 v3, 2, v3
v_add_u32 v3, s48, v3
v_lshlrev_b32 v3, 10, v3
v_and_b32 v4, 7, v2
v_lshrrev_b32 v5, 4, v2
v_xor_b32 v6, v4, v5
v_lshl_add_u32 v10, v6, 4, v3
v_xor_b32 v6, 4, v6
v_lshl_add_u32 v11, v6, 4, v3
s_mul_i32 s47, s44, 10240
s_mov_b32 s22, 2097152
s_mov_b32 s23, 0x20000
s_mov_b32 s26, 1409024
s_mov_b32 s27, 0x20000
s_mov_b32 s30, 1409024
s_mov_b32 s31, 0x20000
s_mov_b32 s38, 1409024
s_mov_b32 s39, 0x20000
s_cmp_ge_u32 s46, 15
s_waitcnt lgkmcnt(0)
s_mov_b64 s[20:21], s[4:5]
s_mov_b64 s[24:25], s[6:7]
s_mov_b64 s[28:29], s[8:9]
s_mov_b64 s[36:37], s[10:11]
s_cbranch_scc1 L_IDLE
s_add_u32 s40, s47, 4096
s_add_u32 s41, s47, 7168
s_add_u32 s48, s73, 0
s_and_b32 s48, s48, 7
s_add_u32 m0, s47, 0
s_lshl_b32 s52, s48, 7
s_mul_i32 s53, s48, 176128
buffer_load_dwordx4 v10, s[20:23], s52 offen offset:0 lds
buffer_load_dwordx4 v11, s[20:23], s52 offen offset:1024 lds
buffer_load_dwordx4 v10, s[20:23], s52 offen offset:2048 lds
buffer_load_dwordx4 v11, s[20:23], s52 offen offset:3072 lds
s_mul_i32 s48, s46, 192
s_mul_i32 s49, s44, 44032
s_add_u32 s48, s48, s49
s_movk_i32 s50, 2752
s_cmp_eq_u32 s46, 14
s_cselect_b32 s51, 4, 12
v_mov_b32 v6, 0x7f000000
v_add_u32 v3, 0, v2
v_mul_u32_u24 v4, 171, v3
v_lshrrev_b32 v4, 11, v4
v_mul_u32_u24 v5, 12, v4
v_sub_u32 v5, v3, v5
v_cmp_le_u32 vcc, s51, v5
v_mul_u32_u24 v4, s50, v4
s_sub_u32 s49, s48, 0
v_add_u32 v4, s49, v4
v_cndmask_b32 v4, v4, v6, vcc
v_lshl_add_u32 v12, v5, 4, v4
v_xor_b32 v5, 2, v5
v_lshl_add_u32 v15, v5, 4, v4
v_add_u32 v3, 64, v2
v_mul_u32_u24 v4, 171, v3
v_lshrrev_b32 v4, 11, v4
v_mul_u32_u24 v5, 12, v4
v_sub_u32 v5, v3, v5
v_cmp_le_u32 vcc, s51, v5
v_mul_u32_u24 v4, s50, v4
s_sub_u32 s49, s48, 1024
v_add_u32 v4, s49, v4
v_cndmask_b32 v4, v4, v6, vcc
v_lshl_add_u32 v13, v5, 4, v4
v_xor_b32 v5, 2, v5
v_lshl_add_u32 v16, v5, 4, v4
v_add_u32 v3, 128, v2
v_mul_u32_u24 v4, 171, v3
v_lshrrev_b32 v4, 11, v4
v_mul_u32_u24 v5, 12, v4
v_sub_u32 v5, v3, v5
v_cmp_le_u32 vcc, s51, v5
v_mul_u32_u24 v4, s50, v4
s_sub_u32 s49, s48, 2048
v_add_u32 v4, s49, v4
v_cndmask_b32 v4, v4, v6, vcc
v_lshl_add_u32 v14, v5, 4, v4
v_xor_b32 v5, 2, v5
v_lshl_add_u32 v17, v5, 4, v4
s_add_u32 m0, s40, 0
s_nop 0
buffer_load_dwordx4 v12, s[24:27], s53 offen offset:0 lds
buffer_load_dwordx4 v13, s[24:27], s53 offen offset:1024 lds
buffer_load_dwordx4 v14, s[24:27], s53 offen offset:2048 lds
s_add_u32 m0, s41, 0
s_nop 0
buffer_load_dwordx4 v15, s[28:31], s53 offen offset:0 lds
buffer_load_dwordx4 v16, s[28:31], s53 offen offset:1024 lds
buffer_load_dwordx4 v17, s[28:31], s53 offen offset:2048 lds
s_setprio 0
s_add_u32 s48, s73, 1
s_and_b32 s48, s48, 7
s_add_u32 m0, s47, 40960
s_lshl_b32 s52, s48, 7
s_mul_i32 s53, s48, 176128
buffer_load_dwordx4 v10, s[20:23], s52 offen offset:0 lds
buffer_load_dwordx4 v11, s[20:23], s52 offen offset:1024 lds
buffer_load_dwordx4 v10, s[20:23], s52 offen offset:2048 lds
buffer_load_dwordx4 v11, s[20:23], s52 offen offset:3072 lds
s_add_u32 m0, s40, 40960
s_nop 0
buffer_load_dwordx4 v12, s[24:27], s53 offen offset:0 lds
buffer_load_dwordx4 v13, s[24:27], s53 offen offset:1024 lds
buffer_load_dwordx4 v14, s[24:27], s53 offen offset:2048 lds
s_add_u32 m0, s41, 40960
s_nop 0
buffer_load_dwordx4 v15, s[28:31], s53 offen offset:0 lds
buffer_load_dwordx4 v16, s[28:31], s53 offen offset:1024 lds
buffer_load_dwordx4 v17, s[28:31], s53 offen offset:2048 lds
s_lshr_b32 s60, s2, 3
s_mul_i32 s48, s60, 43
s_mul_i32 s49, s44, 11
v_add_u32 v3, s49, v2
v_add_u32 v4, s48, v3
s_lshr_b32 s49, s48, 8
s_lshr_b32 s48, s36, 7
s_sub_u32 s48, 3, s48
s_and_b32 s48, s48, 7
s_lshl_b32 s48, s48, 7
v_lshlrev_b32 v24, 10, v4
v_add_u32 v24, s48, v24
s_mul_i32 s49, s49, 6
s_sub_u32 s60, s60, s49
s_add_u32 s60, s60, 1
v_cmp_gt_u32 vcc, 43, v3
v_cmp_gt_u32 s[48:49], 11, v2
s_and_b64 vcc, vcc, s[48:49]
v_mov_b32 v4, 0x7f000000
v_cndmask_b32 v24, v4, v24, vcc
s_cmp_eq_u32 s60, 1
s_cselect_b32 s48, 0, 0x7f000000
buffer_load_dword v25, v24, s[36:39], s48 offen
v_lshrrev_b32 v3, 3, v2
v_lshlrev_b32 v3, 10, v3
s_lshl_b32 s48, s65, 7
v_add_u32 v3, s48, v3
v_and_b32 v4, 7, v2
v_bfe_u32 v5, v2, 4, 1
v_lshlrev_b32 v5, 2, v5
v_xor_b32 v4, v4, v5
v_lshl_add_u32 v18, v4, 4, v3
v_add_u32 v19, 7168, v18
v_add_u32 v20, 14336, v18
v_add_u32 v21, 21504, v18
s_mul_i32 s68, s66, 43
s_mul_i32 s48, s67, 5
s_add_u32 s68, s68, s48
s_lshl_b32 s68, s68, 14
s_mul_i32 s69, s66, 10
s_add_u32 s69, s69, s48
s_lshl_b32 s69, s69, 11
s_waitcnt vmcnt(11)
s_barrier
s_add_u32 s48, s73, 2
s_and_b32 s48, s48, 7
s_add_u32 m0, s47, 81920
s_lshl_b32 s52, s48, 7
s_mul_i32 s53, s48, 176128
buffer_load_dwordx4 v10, s[20:23], s52 offen offset:0 lds
buffer_load_dwordx4 v11, s[20:23], s52 offen offset:1024 lds
buffer_load_dwordx4 v10, s[20:23], s52 offen offset:2048 lds
buffer_load_dwordx4 v11, s[20:23], s52 offen offset:3072 lds
s_add_u32 m0, s40, 81920
s_nop 0
buffer_load_dwordx4 v12, s[24:27], s53 offen offset:0 lds
buffer_load_dwordx4 v13, s[24:27], s53 offen offset:1024 lds
buffer_load_dwordx4 v14, s[24:27], s53 offen offset:2048 lds
s_add_u32 m0, s41, 81920
s_nop 0
buffer_load_dwordx4 v15, s[28:31], s53 offen offset:0 lds
buffer_load_dwordx4 v16, s[28:31], s53 offen offset:1024 lds
buffer_load_dwordx4 v17, s[28:31], s53 offen offset:2048 lds
s_cmp_eq_u32 s60, 2
s_cselect_b32 s48, 0, 0x7f000000
buffer_load_dword v25, v24, s[36:39], s48 offen
s_waitcnt vmcnt(12)
s_barrier
s_add_u32 s48, s73, 3
s_and_b32 s48, s48, 7
s_add_u32 m0, s47, 122880
s_lshl_b32 s52, s48, 7
s_mul_i32 s53, s48, 176128
buffer_load_dwordx4 v10, s[20:23], s52 offen offset:0 lds
buffer_load_dwordx4 v11, s[20:23], s52 offen offset:1024 lds
buffer_load_dwordx4 v10, s[20:23], s52 offen offset:2048 lds
buffer_load_dwordx4 v11, s[20:23], s52 offen offset:3072 lds
s_add_u32 m0, s40, 122880
s_nop 0
buffer_load_dwordx4 v12, s[24:27], s53 offen offset:0 lds
buffer_load_dwordx4 v13, s[24:27], s53 offen offset:1024 lds
buffer_load_dwordx4 v14, s[24:27], s53 offen offset:2048 lds
s_add_u32 m0, s41, 122880
s_nop 0
buffer_load_dwordx4 v15, s[28:31], s53 offen offset:0 lds
buffer_load_dwordx4 v16, s[28:31], s53 offen offset:1024 lds
buffer_load_dwordx4 v17, s[28:31], s53 offen offset:2048 lds
s_cmp_eq_u32 s60, 3
s_cselect_b32 s48, 0, 0x7f000000
buffer_load_dword v25, v24, s[36:39], s48 offen
s_waitcnt vmcnt(12)
s_barrier
s_add_u32 s48, s73, 4
s_and_b32 s48, s48, 7
s_add_u32 m0, s47, 0
s_lshl_b32 s52, s48, 7
s_mul_i32 s53, s48, 176128
buffer_load_dwordx4 v10, s[20:23], s52 offen offset:0 lds
buffer_load_dwordx4 v11, s[20:23], s52 offen offset:1024 lds
buffer_load_dwordx4 v10, s[20:23], s52 offen offset:2048 lds
buffer_load_dwordx4 v11, s[20:23], s52 offen offset:3072 lds
s_add_u32 m0, s40, 0
s_nop 0
buffer_load_dwordx4 v12, s[24:27], s53 offen offset:0 lds
buffer_load_dwordx4 v13, s[24:27], s53 offen offset:1024 lds
buffer_load_dwordx4 v14, s[24:27], s53 offen offset:2048 lds
s_add_u32 m0, s41, 0
s_nop 0
buffer_load_dwordx4 v15, s[28:31], s53 offen offset:0 lds
buffer_load_dwordx4 v16, s[28:31], s53 offen offset:1024 lds
buffer_load_dwordx4 v17, s[28:31], s53 offen offset:2048 lds
s_cmp_eq_u32 s60, 4
s_cselect_b32 s48, 0, 0x7f000000
buffer_load_dword v25, v24, s[36:39], s48 offen
s_waitcnt vmcnt(12)
s_barrier
s_add_u32 s48, s73, 5
s_and_b32 s48, s48, 7
s_add_u32 m0, s47, 40960
s_lshl_b32 s52, s48, 7
s_mul_i32 s53, s48, 176128
buffer_load_dwordx4 v10, s[20:23], s52 offen offset:0 lds
buffer_load_dwordx4 v11, s[20:23], s52 offen offset:1024 lds
buffer_load_dwordx4 v10, s[20:23], s52 offen offset:2048 lds
buffer_load_dwordx4 v11, s[20:23], s52 offen offset:3072 lds
s_add_u32 m0, s40, 40960
s_nop 0
buffer_load_dwordx4 v12, s[24:27], s53 offen offset:0 lds
buffer_load_dwordx4 v13, s[24:27], s53 offen offset:1024 lds
buffer_load_dwordx4 v14, s[24:27], s53 offen offset:2048 lds
s_add_u32 m0, s41, 40960
s_nop 0
buffer_load_dwordx4 v15, s[28:31], s53 offen offset:0 lds
buffer_load_dwordx4 v16, s[28:31], s53 offen offset:1024 lds
buffer_load_dwordx4 v17, s[28:31], s53 offen offset:2048 lds
s_cmp_eq_u32 s60, 5
s_cselect_b32 s48, 0, 0x7f000000
buffer_load_dword v25, v24, s[36:39], s48 offen
s_waitcnt vmcnt(12)
s_barrier
s_add_u32 s48, s73, 6
s_and_b32 s48, s48, 7
s_add_u32 m0, s47, 81920
s_lshl_b32 s52, s48, 7
s_mul_i32 s53, s48, 176128
buffer_load_dwordx4 v10, s[20:23], s52 offen offset:0 lds
buffer_load_dwordx4 v11, s[20:23], s52 offen offset:1024 lds
buffer_load_dwordx4 v10, s[20:23], s52 offen offset:2048 lds
buffer_load_dwordx4 v11, s[20:23], s52 offen offset:3072 lds
s_add_u32 m0, s40, 81920
s_nop 0
buffer_load_dwordx4 v12, s[24:27], s53 offen offset:0 lds
buffer_load_dwordx4 v13, s[24:27], s53 offen offset:1024 lds
buffer_load_dwordx4 v14, s[24:27], s53 offen offset:2048 lds
s_add_u32 m0, s41, 81920
s_nop 0
buffer_load_dwordx4 v15, s[28:31], s53 offen offset:0 lds
buffer_load_dwordx4 v16, s[28:31], s53 offen offset:1024 lds
buffer_load_dwordx4 v17, s[28:31], s53 offen offset:2048 lds
s_cmp_eq_u32 s60, 6
s_cselect_b32 s48, 0, 0x7f000000
buffer_load_dword v25, v24, s[36:39], s48 offen
s_waitcnt vmcnt(12)
s_barrier
s_add_u32 s48, s73, 7
s_and_b32 s48, s48, 7
s_add_u32 m0, s47, 122880
s_lshl_b32 s52, s48, 7
s_mul_i32 s53, s48, 176128
buffer_load_dwordx4 v10, s[20:23], s52 offen offset:0 lds
buffer_load_dwordx4 v11, s[20:23], s52 offen offset:1024 lds
buffer_load_dwordx4 v10, s[20:23], s52 offen offset:2048 lds
buffer_load_dwordx4 v11, s[20:23], s52 offen offset:3072 lds
s_add_u32 m0, s40, 122880
s_nop 0
buffer_load_dwordx4 v12, s[24:27], s53 offen offset:0 lds
buffer_load_dwordx4 v13, s[24:27], s53 offen offset:1024 lds
buffer_load_dwordx4 v14, s[24:27], s53 offen offset:2048 lds
s_add_u32 m0, s41, 122880
s_nop 0
buffer_load_dwordx4 v15, s[28:31], s53 offen offset:0 lds
buffer_load_dwordx4 v16, s[28:31], s53 offen offset:1024 lds
buffer_load_dwordx4 v17, s[28:31], s53 offen offset:2048 lds
s_waitcnt vmcnt(11)
s_barrier
s_add_u32 s71, s81, 0
s_and_b32 s71, s71, 3
s_mul_i32 s71, s71, 163840
s_add_u32 s71, s71, s68
s_add_u32 m0, s69, 0
s_add_u32 s70, s71, 0
buffer_load_dwordx4 v18, s[36:39], s70 offen offset:0 lds
buffer_load_dwordx4 v19, s[36:39], s70 offen offset:1024 lds
buffer_load_dwordx4 v20, s[36:39], s70 offen offset:2048 lds
buffer_load_dwordx4 v21, s[36:39], s70 offen offset:3072 lds
s_add_u32 m0, s69, 4096
s_add_u32 s70, s71, 32768
buffer_load_dwordx4 v18, s[36:39], s70 offen offset:0 lds
buffer_load_dwordx4 v19, s[36:39], s70 offen offset:1024 lds
buffer_load_dwordx4 v20, s[36:39], s70 offen offset:2048 lds
buffer_load_dwordx4 v21, s[36:39], s70 offen offset:3072 lds
s_add_u32 m0, s69, 8192
s_add_u32 s70, s71, 65536
buffer_load_dwordx4 v18, s[36:39], s70 offen offset:0 lds
buffer_load_dwordx4 v19, s[36:39], s70 offen offset:1024 lds
s_waitcnt vmcnt(10)
s_barrier
s_add_u32 s71, s81, 1
s_and_b32 s71, s71, 3
s_mul_i32 s71, s71, 163840
s_add_u32 s71, s71, s68
s_add_u32 m0, s69, 40960
s_add_u32 s70, s71, 0
buffer_load_dwordx4 v18, s[36:39], s70 offen offset:0 lds
buffer_load_dwordx4 v19, s[36:39], s70 offen offset:1024 lds
buffer_load_dwordx4 v20, s[36:39], s70 offen offset:2048 lds
buffer_load_dwordx4 v21, s[36:39], s70 offen offset:3072 lds
s_add_u32 m0, s69, 45056
s_add_u32 s70, s71, 32768
buffer_load_dwordx4 v18, s[36:39], s70 offen offset:0 lds
buffer_load_dwordx4 v19, s[36:39], s70 offen offset:1024 lds
buffer_load_dwordx4 v20, s[36:39], s70 offen offset:2048 lds
buffer_load_dwordx4 v21, s[36:39], s70 offen offset:3072 lds
s_add_u32 m0, s69, 49152
s_add_u32 s70, s71, 65536
buffer_load_dwordx4 v18, s[36:39], s70 offen offset:0 lds
buffer_load_dwordx4 v19, s[36:39], s70 offen offset:1024 lds
s_barrier
s_add_u32 s71, s81, 2
s_and_b32 s71, s71, 3
s_mul_i32 s71, s71, 163840
s_add_u32 s71, s71, s68
s_add_u32 m0, s69, 81920
s_add_u32 s70, s71, 0
buffer_load_dwordx4 v18, s[36:39], s70 offen offset:0 lds
buffer_load_dwordx4 v19, s[36:39], s70 offen offset:1024 lds
buffer_load_dwordx4 v20, s[36:39], s70 offen offset:2048 lds
buffer_load_dwordx4 v21, s[36:39], s70 offen offset:3072 lds
s_add_u32 m0, s69, 86016
s_add_u32 s70, s71, 32768
buffer_load_dwordx4 v18, s[36:39], s70 offen offset:0 lds
buffer_load_dwordx4 v19, s[36:39], s70 offen offset:1024 lds
buffer_load_dwordx4 v20, s[36:39], s70 offen offset:2048 lds
buffer_load_dwordx4 v21, s[36:39], s70 offen offset:3072 lds
s_add_u32 m0, s69, 90112
s_add_u32 s70, s71, 65536
buffer_load_dwordx4 v18, s[36:39], s70 offen offset:0 lds
buffer_load_dwordx4 v19, s[36:39], s70 offen offset:1024 lds
s_add_u32 s71, s81, 3
s_and_b32 s71, s71, 3
s_mul_i32 s71, s71, 163840
s_add_u32 s71, s71, s68
s_barrier
s_add_u32 m0, s69, 122880
s_add_u32 s70, s71, 0
buffer_load_dwordx4 v18, s[36:39], s70 offen offset:0 lds
buffer_load_dwordx4 v19, s[36:39], s70 offen offset:1024 lds
buffer_load_dwordx4 v20, s[36:39], s70 offen offset:2048 lds
buffer_load_dwordx4 v21, s[36:39], s70 offen offset:3072 lds
s_add_u32 m0, s69, 126976
s_add_u32 s70, s71, 32768
buffer_load_dwordx4 v18, s[36:39], s70 offen offset:0 lds
buffer_load_dwordx4 v19, s[36:39], s70 offen offset:1024 lds
buffer_load_dwordx4 v20, s[36:39], s70 offen offset:2048 lds
buffer_load_dwordx4 v21, s[36:39], s70 offen offset:3072 lds
s_add_u32 m0, s69, 131072
s_add_u32 s70, s71, 65536
buffer_load_dwordx4 v18, s[36:39], s70 offen offset:0 lds
buffer_load_dwordx4 v19, s[36:39], s70 offen offset:1024 lds
s_branch L_P2
L_IDLE:
s_setprio 0
s_mul_i32 s48, s45, 88064
s_lshl_b32 s49, s44, 13
s_add_u32 s48, s48, s49
v_lshlrev_b32 v3, 7, v2
buffer_load_dword v25, v3, s[36:39], s48 offen
s_add_u32 s48, s48, 32768
buffer_load_dword v25, v3, s[36:39], s48 offen
s_add_u32 s48, s48, 32768
buffer_load_dword v25, v3, s[36:39], s48 offen
v_lshrrev_b32 v3, 3, v2
v_lshlrev_b32 v3, 10, v3
s_lshl_b32 s48, s65, 7
v_add_u32 v3, s48, v3
v_and_b32 v4, 7, v2
v_bfe_u32 v5, v2, 4, 1
v_lshlrev_b32 v5, 2, v5
v_xor_b32 v4, v4, v5
v_lshl_add_u32 v18, v4, 4, v3
v_add_u32 v19, 7168, v18
v_add_u32 v20, 14336, v18
v_add_u32 v21, 21504, v18
s_mul_i32 s68, s66, 43
s_mul_i32 s48, s67, 5
s_add_u32 s68, s68, s48
s_lshl_b32 s68, s68, 14
s_mul_i32 s69, s66, 10
s_add_u32 s69, s69, s48
s_lshl_b32 s69, s69, 11
s_lshr_b32 s60, s2, 3
s_mul_i32 s48, s60, 43
s_mul_i32 s49, s44, 11
v_add_u32 v3, s49, v2
v_add_u32 v4, s48, v3
s_lshr_b32 s49, s48, 8
s_lshr_b32 s48, s36, 7
s_sub_u32 s48, 3, s48
s_and_b32 s48, s48, 7
s_lshl_b32 s48, s48, 7
v_lshlrev_b32 v24, 10, v4
v_add_u32 v24, s48, v24
s_mul_i32 s49, s49, 6
s_sub_u32 s60, s60, s49
s_add_u32 s60, s60, 1
v_cmp_gt_u32 vcc, 43, v3
v_cmp_gt_u32 s[48:49], 11, v2
s_and_b64 vcc, vcc, s[48:49]
v_mov_b32 v4, 0x7f000000
v_cndmask_b32 v24, v4, v24, vcc
buffer_load_dword v25, v24, s[36:39], 0 offen
s_barrier
s_add_u32 s71, s81, 0
s_and_b32 s71, s71, 3
s_mul_i32 s71, s71, 163840
s_add_u32 s71, s71, s68
s_add_u32 m0, s69, 0
s_add_u32 s70, s71, 0
buffer_load_dwordx4 v18, s[36:39], s70 offen offset:0 lds
buffer_load_dwordx4 v19, s[36:39], s70 offen offset:1024 lds
buffer_load_dwordx4 v20, s[36:39], s70 offen offset:2048 lds
buffer_load_dwordx4 v21, s[36:39], s70 offen offset:3072 lds
s_add_u32 m0, s69, 4096
s_add_u32 s70, s71, 32768
buffer_load_dwordx4 v18, s[36:39], s70 offen offset:0 lds
buffer_load_dwordx4 v19, s[36:39], s70 offen offset:1024 lds
buffer_load_dwordx4 v20, s[36:39], s70 offen offset:2048 lds
buffer_load_dwordx4 v21, s[36:39], s70 offen offset:3072 lds
s_add_u32 m0, s69, 8192
s_add_u32 s70, s71, 65536
buffer_load_dwordx4 v18, s[36:39], s70 offen offset:0 lds
buffer_load_dwordx4 v19, s[36:39], s70 offen offset:1024 lds
s_add_u32 s71, s81, 1
s_and_b32 s71, s71, 3
s_mul_i32 s71, s71, 163840
s_add_u32 s71, s71, s68
s_add_u32 m0, s69, 40960
s_add_u32 s70, s71, 0
buffer_load_dwordx4 v18, s[36:39], s70 offen offset:0 lds
buffer_load_dwordx4 v19, s[36:39], s70 offen offset:1024 lds
buffer_load_dwordx4 v20, s[36:39], s70 offen offset:2048 lds
buffer_load_dwordx4 v21, s[36:39], s70 offen offset:3072 lds
s_add_u32 m0, s69, 45056
s_add_u32 s70, s71, 32768
buffer_load_dwordx4 v18, s[36:39], s70 offen offset:0 lds
buffer_load_dwordx4 v19, s[36:39], s70 offen offset:1024 lds
buffer_load_dwordx4 v20, s[36:39], s70 offen offset:2048 lds
buffer_load_dwordx4 v21, s[36:39], s70 offen offset:3072 lds
s_add_u32 m0, s69, 49152
s_add_u32 s70, s71, 65536
buffer_load_dwordx4 v18, s[36:39], s70 offen offset:0 lds
buffer_load_dwordx4 v19, s[36:39], s70 offen offset:1024 lds
s_add_u32 s71, s81, 2
s_and_b32 s71, s71, 3
s_mul_i32 s71, s71, 163840
s_add_u32 s71, s71, s68
s_add_u32 m0, s69, 81920
s_add_u32 s70, s71, 0
buffer_load_dwordx4 v18, s[36:39], s70 offen offset:0 lds
buffer_load_dwordx4 v19, s[36:39], s70 offen offset:1024 lds
buffer_load_dwordx4 v20, s[36:39], s70 offen offset:2048 lds
buffer_load_dwordx4 v21, s[36:39], s70 offen offset:3072 lds
s_add_u32 m0, s69, 86016
s_add_u32 s70, s71, 32768
buffer_load_dwordx4 v18, s[36:39], s70 offen offset:0 lds
buffer_load_dwordx4 v19, s[36:39], s70 offen offset:1024 lds
buffer_load_dwordx4 v20, s[36:39], s70 offen offset:2048 lds
buffer_load_dwordx4 v21, s[36:39], s70 offen offset:3072 lds
s_add_u32 m0, s69, 90112
s_add_u32 s70, s71, 65536
buffer_load_dwordx4 v18, s[36:39], s70 offen offset:0 lds
buffer_load_dwordx4 v19, s[36:39], s70 offen offset:1024 lds
s_add_u32 s71, s81, 3
s_and_b32 s71, s71, 3
s_mul_i32 s71, s71, 163840
s_add_u32 s71, s71, s68
s_add_u32 m0, s69, 122880
s_add_u32 s70, s71, 0
buffer_load_dwordx4 v18, s[36:39], s70 offen offset:0 lds
buffer_load_dwordx4 v19, s[36:39], s70 offen offset:1024 lds
buffer_load_dwordx4 v20, s[36:39], s70 offen offset:2048 lds
buffer_load_dwordx4 v21, s[36:39], s70 offen offset:3072 lds
s_add_u32 m0, s69, 126976
s_add_u32 s70, s71, 32768
buffer_load_dwordx4 v18, s[36:39], s70 offen offset:0 lds
buffer_load_dwordx4 v19, s[36:39], s70 offen offset:1024 lds
buffer_load_dwordx4 v20, s[36:39], s70 offen offset:2048 lds
buffer_load_dwordx4 v21, s[36:39], s70 offen offset:3072 lds
s_add_u32 m0, s69, 131072
s_add_u32 s70, s71, 65536
buffer_load_dwordx4 v18, s[36:39], s70 offen offset:0 lds
buffer_load_dwordx4 v19, s[36:39], s70 offen offset:1024 lds
L_P2:
s_waitcnt vmcnt(0)
s_barrier
s_barrier
s_mul_i32 s70, s66, 20480
s_mul_i32 s71, s67, 3072
s_add_u32 m0, s70, s71
s_mul_i32 s70, s66, 43
s_add_u32 s70, s70, 40
s_lshl_b32 s70, s70, 14
s_mul_i32 s71, s67, 24576
s_add_u32 s70, s70, s71
buffer_load_dwordx4 v18, s[36:39], s70 offen offset:0 lds
buffer_load_dwordx4 v19, s[36:39], s70 offen offset:1024 lds
buffer_load_dwordx4 v20, s[36:39], s70 offen offset:2048 lds
s_waitcnt vmcnt(0)
s_barrier
s_endpgm
COMPUTE:
s_mul_i32 s50, s67, 20480
v_and_b32 v3, 31, v2
v_lshrrev_b32 v7, 5, v2
v_bfe_u32 v5, v2, 1, 3
v_xor_b32 v5, v5, v7
v_lshlrev_b32 v6, 7, v3
v_add_u32 v6, s50, v6
v_lshl_add_u32 v18, v5, 4, v6
v_xor_b32 v19, 32, v18
v_xor_b32 v20, 64, v18
v_xor_b32 v21, 96, v18
v_bfe_u32 v3, v2, 4, 1
v_bfe_u32 v5, v2, 2, 2
v_lshl_add_u32 v5, v7, 3, v5
v_mul_u32_u24 v5, 192, v5
v_mul_u32_u24 v6, 3072, v3
v_add3_u32 v5, v5, v6, 0
v_add_u32 v5, 4096, v5
v_and_b32 v6, 1, v2
v_lshl_add_u32 v5, v6, 4, v5
v_bfe_u32 v6, v2, 1, 1
v_lshl_add_u32 v5, v6, 3, v5
s_mul_i32 s50, s66, 3
s_add_u32 s51, s50, 0
v_xor_b32 v6, s51, v3
v_lshl_add_u32 v22, v6, 5, v5
s_add_u32 s51, s50, 1
v_xor_b32 v6, s51, v3
v_lshl_add_u32 v23, v6, 5, v5
s_add_u32 s51, s50, 2
v_xor_b32 v6, s51, v3
v_lshl_add_u32 v24, v6, 5, v5
v_lshlrev_b32 v25, 4, v2
v_mov_b32 v26, 0xc0135761
v_mov_b32 v27, 0xc0135761
v_mov_b32 v28, 1.0
v_mov_b32 v29, 1.0
s_mov_b32 s54, 0xbdd2d3e8
s_mov_b32 s55, 0xbdd2d3e8
s_lshl_b32 s50, s45, 2
s_lshl_b32 s51, s67, 1
s_add_u32 s50, s50, s51
s_mul_i32 s50, s50, 86
s_mul_i32 s51, s46, 6
s_mul_i32 s62, s66, 3
s_add_u32 s51, s51, s62
s_add_u32 s62, s51, 0
s_add_u32 s63, s50, s62
s_lshl_b32 s63, s63, 10
s_cmp_lt_u32 s62, 86
s_cselect_b32 s28, s63, 0x7f000000
s_add_u32 s63, s63, 88064
s_cmp_lt_u32 s62, 86
s_cselect_b32 s29, s63, 0x7f000000
s_add_u32 s62, s51, 1
s_add_u32 s63, s50, s62
s_lshl_b32 s63, s63, 10
s_cmp_lt_u32 s62, 86
s_cselect_b32 s30, s63, 0x7f000000
s_add_u32 s63, s63, 88064
s_cmp_lt_u32 s62, 86
s_cselect_b32 s31, s63, 0x7f000000
s_add_u32 s62, s51, 2
s_add_u32 s63, s50, s62
s_lshl_b32 s63, s63, 10
s_cmp_lt_u32 s62, 86
s_cselect_b32 s36, s63, 0x7f000000
s_add_u32 s63, s63, 88064
s_cmp_lt_u32 s62, 86
s_cselect_b32 s37, s63, 0x7f000000
v_bfe_u32 v5, v2, 2, 2
v_lshl_add_u32 v3, v7, 3, v5
v_lshlrev_b32 v3, 7, v3
v_bfe_u32 v5, v2, 3, 1
v_lshl_add_u32 v3, v5, 6, v3
v_and_b32 v5, 1, v2
v_lshl_add_u32 v3, v5, 5, v3
v_bfe_u32 v5, v2, 4, 1
v_lshl_add_u32 v3, v5, 4, v3
v_bfe_u32 v5, v2, 1, 1
v_lshl_add_u32 v3, v5, 3, v3
s_mul_i32 s48, s66, 20480
v_add_u32 v8, s48, v3
v_xor_b32 v11, 64, v8
v_add_u32 v9, 61440, v8
v_add_u32 v10, 122880, v8
v_add_u32 v12, 61440, v11
v_add_u32 v13, 122880, v11
s_lshl_b32 s72, s64, 1
s_add_u32 s72, s72, s67
s_mul_i32 s72, s72, 86
s_mul_i32 s48, s66, 43
s_add_u32 s72, s72, s48
s_lshl_b32 s72, s72, 10
s_add_u32 s48, s81, 0
s_and_b32 s48, s48, 3
s_mul_i32 s48, s48, 10240
s_add_u32 s60, s72, s48
s_add_u32 s48, s81, 1
s_and_b32 s48, s48, 3
s_mul_i32 s48, s48, 10240
s_add_u32 s61, s72, s48
s_add_u32 s48, s81, 2
s_and_b32 s48, s48, 3
s_mul_i32 s48, s48, 10240
s_add_u32 s62, s72, s48
s_add_u32 s48, s81, 3
s_and_b32 s48, s48, 3
s_mul_i32 s48, s48, 10240
s_add_u32 s63, s72, s48
v_and_b32 v3, 7, v2
v_lshlrev_b32 v3, 2, v3
v_bfe_u32 v5, v2, 3, 2
v_add_u32 v3, v3, v5
s_lshl_b32 s48, s64, 6
s_lshl_b32 s49, s67, 5
s_add_u32 s48, s48, s49
v_add_u32 v3, s48, v3
v_lshlrev_b32 v3, 10, v3
v_lshl_add_u32 v3, v7, 5, v3
s_lshl_b32 s48, s65, 7
s_lshl_b32 s49, s66, 6
s_add_u32 s48, s48, s49
v_add_u32 v14, s48, v3
v_min_u32 v3, 14, v2
s_lshl_b32 s48, s64, 5
s_mul_i32 s49, s66, 14
s_add_u32 s48, s48, s49
v_add_u32 v3, s48, v3
v_lshlrev_b32 v15, 3, v3
s_lshl_b32 s48, s45, 1
s_add_u32 s48, s48, s67
s_lshl_b32 s48, s48, 5
s_lshl_b32 s49, s46, 1
s_add_u32 s48, s48, s49
s_add_u32 s48, s48, s66
s_lshl_b32 s48, s48, 3
v_mov_b32 v16, s48
s_mul_i32 s48, s66, 20480
s_lshl_b32 s49, s67, 12
s_add_u32 s48, s48, s49
s_add_u32 s48, s48, 6144
v_add_u32 v6, s48, v25
s_xor_b32 s50, s66, 1
s_mul_i32 s48, s50, 20480
s_add_u32 s48, s48, s49
s_add_u32 s48, s48, 6144
v_add_u32 v7, s48, v25
v_mov_b32 v17, 0
s_getreg_b32 s71, hwreg(HW_REG_XCC_ID)
s_and_b32 s71, s71, 7
s_and_b32 s48, s2, 7
s_lshl_b32 s48, s48, 8
s_add_u32 s48, s48, 65536
v_and_b32 v3, 31, v2
v_lshl_add_u32 v1, v3, 3, s48
s_lshr_b32 s49, s2, 3
s_lshl_b32 s49, s49, 3
s_add_u32 s70, s48, s49
s_waitcnt lgkmcnt(0)
s_mov_b32 s32, s16
s_mov_b32 s33, s17
s_mov_b32 s34, 5636096
s_mov_b32 s35, 0x20000
s_mov_b32 s40, s12
s_mov_b32 s41, s13
s_mov_b32 s42, 2097152
s_mov_b32 s43, 0x20000
s_mov_b32 s20, s14
s_mov_b32 s21, s15
s_mov_b32 s22, 256
s_mov_b32 s23, 0x20000
s_add_u32 s24, s16, 6291456
s_addc_u32 s25, s17, 0
s_mov_b32 s26, 67584
s_mov_b32 s27, 0x20000
s_xor_b32 s48, s2, 248
s_or_b32 s48, s48, s75
s_cmp_eq_u32 s48, 0
s_cbranch_scc0 NO_PUB
s_memrealtime s[48:49]
s_waitcnt lgkmcnt(0)
s_lshl_b64 s[48:49], s[48:49], 3
s_or_b32 s49, s49, 0x80000000
v_mov_b32 v4, s48
v_mov_b32 v5, s49
buffer_store_dwordx2 v[4:5], v17, s[20:23], 0 offen sc1
NO_PUB:
s_setprio 2
s_cmp_ge_u32 s46, 15
s_cbranch_scc1 C_IDLE
s_barrier
ds_read_b128 v[32:35], v18 offset:0
ds_read_b128 v[36:39], v18 offset:10240
ds_read_b64_tr_b16 v[40:41], v22 offset:0
ds_read_b64_tr_b16 v[42:43], v22 offset:768
ds_read_b64_tr_b16 v[44:45], v23 offset:0
ds_read_b64_tr_b16 v[46:47], v23 offset:768
ds_read_b64_tr_b16 v[48:49], v24 offset:0
ds_read_b64_tr_b16 v[50:51], v24 offset:768
ds_read_b128 v[52:55], v19 offset:0
ds_read_b128 v[56:59], v19 offset:10240
ds_read_b64_tr_b16 v[60:61], v22 offset:10240
ds_read_b64_tr_b16 v[62:63], v22 offset:11008
ds_read_b64_tr_b16 v[64:65], v23 offset:10240
ds_read_b64_tr_b16 v[66:67], v23 offset:11008
ds_read_b64_tr_b16 v[68:69], v24 offset:10240
ds_read_b64_tr_b16 v[70:71], v24 offset:11008
s_waitcnt lgkmcnt(8)
v_mfma_f32_32x32x16_bf16 v[132:147], v[40:43], v[32:35], 0
ds_read_b128 v[72:75], v20 offset:0
ds_read_b128 v[76:79], v20 offset:10240
v_mfma_f32_32x32x16_bf16 v[148:163], v[40:43], v[36:39], 0
ds_read_b64_tr_b16 v[80:81], v22 offset:20480
ds_read_b64_tr_b16 v[82:83], v22 offset:21248
v_mfma_f32_32x32x16_bf16 v[164:179], v[44:47], v[32:35], 0
ds_read_b64_tr_b16 v[84:85], v23 offset:20480
ds_read_b64_tr_b16 v[86:87], v23 offset:21248
v_mfma_f32_32x32x16_bf16 v[180:195], v[44:47], v[36:39], 0
ds_read_b64_tr_b16 v[88:89], v24 offset:20480
ds_read_b64_tr_b16 v[90:91], v24 offset:21248
v_mfma_f32_32x32x16_bf16 v[196:211], v[48:51], v[32:35], 0
v_mfma_f32_32x32x16_bf16 v[212:227], v[48:51], v[36:39], 0
s_waitcnt lgkmcnt(8)
v_mfma_f32_32x32x16_bf16 v[132:147], v[60:63], v[52:55], v[132:147]
ds_read_b128 v[92:95], v21 offset:0
ds_read_b128 v[96:99], v21 offset:10240
v_mfma_f32_32x32x16_bf16 v[148:163], v[60:63], v[56:59], v[148:163]
ds_read_b64_tr_b16 v[100:101], v22 offset:30720
ds_read_b64_tr_b16 v[102:103], v22 offset:31488
v_mfma_f32_32x32x16_bf16 v[164:179], v[64:67], v[52:55], v[164:179]
ds_read_b64_tr_b16 v[104:105], v23 offset:30720
ds_read_b64_tr_b16 v[106:107], v23 offset:31488
v_mfma_f32_32x32x16_bf16 v[180:195], v[64:67], v[56:59], v[180:195]
ds_read_b64_tr_b16 v[108:109], v24 offset:30720
ds_read_b64_tr_b16 v[110:111], v24 offset:31488
v_mfma_f32_32x32x16_bf16 v[196:211], v[68:71], v[52:55], v[196:211]
v_mfma_f32_32x32x16_bf16 v[212:227], v[68:71], v[56:59], v[212:227]
s_waitcnt lgkmcnt(8)
v_mfma_f32_32x32x16_bf16 v[132:147], v[80:83], v[72:75], v[132:147]
v_mfma_f32_32x32x16_bf16 v[148:163], v[80:83], v[76:79], v[148:163]
v_mfma_f32_32x32x16_bf16 v[164:179], v[84:87], v[72:75], v[164:179]
v_mfma_f32_32x32x16_bf16 v[180:195], v[84:87], v[76:79], v[180:195]
v_mfma_f32_32x32x16_bf16 v[196:211], v[88:91], v[72:75], v[196:211]
v_mfma_f32_32x32x16_bf16 v[212:227], v[88:91], v[76:79], v[212:227]
s_waitcnt lgkmcnt(0)
v_add_u32 v18, 40960, v18
v_add_u32 v19, 40960, v19
v_add_u32 v20, 40960, v20
v_add_u32 v21, 40960, v21
v_add_u32 v22, 40960, v22
v_add_u32 v23, 40960, v23
v_add_u32 v24, 40960, v24
s_barrier
v_mfma_f32_32x32x16_bf16 v[132:147], v[100:103], v[92:95], v[132:147]
ds_read_b128 v[112:115], v18 offset:0
ds_read_b128 v[116:119], v18 offset:10240
ds_read_b64_tr_b16 v[120:121], v22 offset:0
v_mfma_f32_32x32x16_bf16 v[148:163], v[100:103], v[96:99], v[148:163]
ds_read_b64_tr_b16 v[122:123], v22 offset:768
ds_read_b64_tr_b16 v[124:125], v23 offset:0
ds_read_b64_tr_b16 v[126:127], v23 offset:768
v_mfma_f32_32x32x16_bf16 v[164:179], v[104:107], v[92:95], v[164:179]
ds_read_b64_tr_b16 v[128:129], v24 offset:0
ds_read_b64_tr_b16 v[130:131], v24 offset:768
ds_read_b128 v[32:35], v19 offset:0
v_mfma_f32_32x32x16_bf16 v[180:195], v[104:107], v[96:99], v[180:195]
ds_read_b128 v[36:39], v19 offset:10240
ds_read_b64_tr_b16 v[40:41], v22 offset:10240
ds_read_b64_tr_b16 v[42:43], v22 offset:11008
v_mfma_f32_32x32x16_bf16 v[196:211], v[108:111], v[92:95], v[196:211]
ds_read_b64_tr_b16 v[44:45], v23 offset:10240
ds_read_b64_tr_b16 v[46:47], v23 offset:11008
ds_read_b64_tr_b16 v[48:49], v24 offset:10240
v_mfma_f32_32x32x16_bf16 v[212:227], v[108:111], v[96:99], v[212:227]
ds_read_b64_tr_b16 v[50:51], v24 offset:11008
s_waitcnt lgkmcnt(8)
v_mfma_f32_32x32x16_bf16 v[132:147], v[120:123], v[112:115], v[132:147]
ds_read_b128 v[52:55], v20 offset:0
ds_read_b128 v[56:59], v20 offset:10240
v_mfma_f32_32x32x16_bf16 v[148:163], v[120:123], v[116:119], v[148:163]
ds_read_b64_tr_b16 v[60:61], v22 offset:20480
ds_read_b64_tr_b16 v[62:63], v22 offset:21248
v_mfma_f32_32x32x16_bf16 v[164:179], v[124:127], v[112:115], v[164:179]
ds_read_b64_tr_b16 v[64:65], v23 offset:20480
ds_read_b64_tr_b16 v[66:67], v23 offset:21248
v_mfma_f32_32x32x16_bf16 v[180:195], v[124:127], v[116:119], v[180:195]
ds_read_b64_tr_b16 v[68:69], v24 offset:20480
ds_read_b64_tr_b16 v[70:71], v24 offset:21248
v_mfma_f32_32x32x16_bf16 v[196:211], v[128:131], v[112:115], v[196:211]
v_mfma_f32_32x32x16_bf16 v[212:227], v[128:131], v[116:119], v[212:227]
s_waitcnt lgkmcnt(8)
v_mfma_f32_32x32x16_bf16 v[132:147], v[40:43], v[32:35], v[132:147]
ds_read_b128 v[72:75], v21 offset:0
ds_read_b128 v[76:79], v21 offset:10240
v_mfma_f32_32x32x16_bf16 v[148:163], v[40:43], v[36:39], v[148:163]
ds_read_b64_tr_b16 v[80:81], v22 offset:30720
ds_read_b64_tr_b16 v[82:83], v22 offset:31488
v_mfma_f32_32x32x16_bf16 v[164:179], v[44:47], v[32:35], v[164:179]
ds_read_b64_tr_b16 v[84:85], v23 offset:30720
ds_read_b64_tr_b16 v[86:87], v23 offset:31488
v_mfma_f32_32x32x16_bf16 v[180:195], v[44:47], v[36:39], v[180:195]
ds_read_b64_tr_b16 v[88:89], v24 offset:30720
ds_read_b64_tr_b16 v[90:91], v24 offset:31488
v_mfma_f32_32x32x16_bf16 v[196:211], v[48:51], v[32:35], v[196:211]
v_mfma_f32_32x32x16_bf16 v[212:227], v[48:51], v[36:39], v[212:227]
s_waitcnt lgkmcnt(8)
v_mfma_f32_32x32x16_bf16 v[132:147], v[60:63], v[52:55], v[132:147]
v_mfma_f32_32x32x16_bf16 v[148:163], v[60:63], v[56:59], v[148:163]
v_mfma_f32_32x32x16_bf16 v[164:179], v[64:67], v[52:55], v[164:179]
v_mfma_f32_32x32x16_bf16 v[180:195], v[64:67], v[56:59], v[180:195]
v_mfma_f32_32x32x16_bf16 v[196:211], v[68:71], v[52:55], v[196:211]
v_mfma_f32_32x32x16_bf16 v[212:227], v[68:71], v[56:59], v[212:227]
s_waitcnt lgkmcnt(0)
v_add_u32 v18, 40960, v18
v_add_u32 v19, 40960, v19
v_add_u32 v20, 40960, v20
v_add_u32 v21, 40960, v21
v_add_u32 v22, 40960, v22
v_add_u32 v23, 40960, v23
v_add_u32 v24, 40960, v24
s_barrier
v_mfma_f32_32x32x16_bf16 v[132:147], v[80:83], v[72:75], v[132:147]
ds_read_b128 v[92:95], v18 offset:0
ds_read_b128 v[96:99], v18 offset:10240
ds_read_b64_tr_b16 v[100:101], v22 offset:0
v_mfma_f32_32x32x16_bf16 v[148:163], v[80:83], v[76:79], v[148:163]
ds_read_b64_tr_b16 v[102:103], v22 offset:768
ds_read_b64_tr_b16 v[104:105], v23 offset:0
ds_read_b64_tr_b16 v[106:107], v23 offset:768
v_mfma_f32_32x32x16_bf16 v[164:179], v[84:87], v[72:75], v[164:179]
ds_read_b64_tr_b16 v[108:109], v24 offset:0
ds_read_b64_tr_b16 v[110:111], v24 offset:768
ds_read_b128 v[112:115], v19 offset:0
v_mfma_f32_32x32x16_bf16 v[180:195], v[84:87], v[76:79], v[180:195]
ds_read_b128 v[116:119], v19 offset:10240
ds_read_b64_tr_b16 v[120:121], v22 offset:10240
ds_read_b64_tr_b16 v[122:123], v22 offset:11008
v_mfma_f32_32x32x16_bf16 v[196:211], v[88:91], v[72:75], v[196:211]
ds_read_b64_tr_b16 v[124:125], v23 offset:10240
ds_read_b64_tr_b16 v[126:127], v23 offset:11008
ds_read_b64_tr_b16 v[128:129], v24 offset:10240
v_mfma_f32_32x32x16_bf16 v[212:227], v[88:91], v[76:79], v[212:227]
ds_read_b64_tr_b16 v[130:131], v24 offset:11008
s_waitcnt lgkmcnt(8)
v_mfma_f32_32x32x16_bf16 v[132:147], v[100:103], v[92:95], v[132:147]
ds_read_b128 v[32:35], v20 offset:0
ds_read_b128 v[36:39], v20 offset:10240
v_mfma_f32_32x32x16_bf16 v[148:163], v[100:103], v[96:99], v[148:163]
ds_read_b64_tr_b16 v[40:41], v22 offset:20480
ds_read_b64_tr_b16 v[42:43], v22 offset:21248
v_mfma_f32_32x32x16_bf16 v[164:179], v[104:107], v[92:95], v[164:179]
ds_read_b64_tr_b16 v[44:45], v23 offset:20480
ds_read_b64_tr_b16 v[46:47], v23 offset:21248
v_mfma_f32_32x32x16_bf16 v[180:195], v[104:107], v[96:99], v[180:195]
ds_read_b64_tr_b16 v[48:49], v24 offset:20480
ds_read_b64_tr_b16 v[50:51], v24 offset:21248
v_mfma_f32_32x32x16_bf16 v[196:211], v[108:111], v[92:95], v[196:211]
v_mfma_f32_32x32x16_bf16 v[212:227], v[108:111], v[96:99], v[212:227]
s_waitcnt lgkmcnt(8)
v_mfma_f32_32x32x16_bf16 v[132:147], v[120:123], v[112:115], v[132:147]
ds_read_b128 v[52:55], v21 offset:0
ds_read_b128 v[56:59], v21 offset:10240
v_mfma_f32_32x32x16_bf16 v[148:163], v[120:123], v[116:119], v[148:163]
ds_read_b64_tr_b16 v[60:61], v22 offset:30720
ds_read_b64_tr_b16 v[62:63], v22 offset:31488
v_mfma_f32_32x32x16_bf16 v[164:179], v[124:127], v[112:115], v[164:179]
ds_read_b64_tr_b16 v[64:65], v23 offset:30720
ds_read_b64_tr_b16 v[66:67], v23 offset:31488
v_mfma_f32_32x32x16_bf16 v[180:195], v[124:127], v[116:119], v[180:195]
ds_read_b64_tr_b16 v[68:69], v24 offset:30720
ds_read_b64_tr_b16 v[70:71], v24 offset:31488
v_mfma_f32_32x32x16_bf16 v[196:211], v[128:131], v[112:115], v[196:211]
v_mfma_f32_32x32x16_bf16 v[212:227], v[128:131], v[116:119], v[212:227]
s_waitcnt lgkmcnt(8)
v_mfma_f32_32x32x16_bf16 v[132:147], v[40:43], v[32:35], v[132:147]
v_mfma_f32_32x32x16_bf16 v[148:163], v[40:43], v[36:39], v[148:163]
v_mfma_f32_32x32x16_bf16 v[164:179], v[44:47], v[32:35], v[164:179]
v_mfma_f32_32x32x16_bf16 v[180:195], v[44:47], v[36:39], v[180:195]
v_mfma_f32_32x32x16_bf16 v[196:211], v[48:51], v[32:35], v[196:211]
v_mfma_f32_32x32x16_bf16 v[212:227], v[48:51], v[36:39], v[212:227]
s_waitcnt lgkmcnt(0)
v_add_u32 v18, 40960, v18
v_add_u32 v19, 40960, v19
v_add_u32 v20, 40960, v20
v_add_u32 v21, 40960, v21
v_add_u32 v22, 40960, v22
v_add_u32 v23, 40960, v23
v_add_u32 v24, 40960, v24
s_barrier
v_mfma_f32_32x32x16_bf16 v[132:147], v[60:63], v[52:55], v[132:147]
ds_read_b128 v[72:75], v18 offset:0
ds_read_b128 v[76:79], v18 offset:10240
ds_read_b64_tr_b16 v[80:81], v22 offset:0
v_mfma_f32_32x32x16_bf16 v[148:163], v[60:63], v[56:59], v[148:163]
ds_read_b64_tr_b16 v[82:83], v22 offset:768
ds_read_b64_tr_b16 v[84:85], v23 offset:0
ds_read_b64_tr_b16 v[86:87], v23 offset:768
v_mfma_f32_32x32x16_bf16 v[164:179], v[64:67], v[52:55], v[164:179]
ds_read_b64_tr_b16 v[88:89], v24 offset:0
ds_read_b64_tr_b16 v[90:91], v24 offset:768
ds_read_b128 v[92:95], v19 offset:0
v_mfma_f32_32x32x16_bf16 v[180:195], v[64:67], v[56:59], v[180:195]
ds_read_b128 v[96:99], v19 offset:10240
ds_read_b64_tr_b16 v[100:101], v22 offset:10240
ds_read_b64_tr_b16 v[102:103], v22 offset:11008
v_mfma_f32_32x32x16_bf16 v[196:211], v[68:71], v[52:55], v[196:211]
ds_read_b64_tr_b16 v[104:105], v23 offset:10240
ds_read_b64_tr_b16 v[106:107], v23 offset:11008
ds_read_b64_tr_b16 v[108:109], v24 offset:10240
v_mfma_f32_32x32x16_bf16 v[212:227], v[68:71], v[56:59], v[212:227]
ds_read_b64_tr_b16 v[110:111], v24 offset:11008
s_waitcnt lgkmcnt(8)
buffer_load_dwordx2 v[30:31], v17, s[20:23], 0 offen sc1
v_mfma_f32_32x32x16_bf16 v[132:147], v[80:83], v[72:75], v[132:147]
ds_read_b128 v[112:115], v20 offset:0
ds_read_b128 v[116:119], v20 offset:10240
v_mfma_f32_32x32x16_bf16 v[148:163], v[80:83], v[76:79], v[148:163]
ds_read_b64_tr_b16 v[120:121], v22 offset:20480
ds_read_b64_tr_b16 v[122:123], v22 offset:21248
v_mfma_f32_32x32x16_bf16 v[164:179], v[84:87], v[72:75], v[164:179]
ds_read_b64_tr_b16 v[124:125], v23 offset:20480
ds_read_b64_tr_b16 v[126:127], v23 offset:21248
v_mfma_f32_32x32x16_bf16 v[180:195], v[84:87], v[76:79], v[180:195]
ds_read_b64_tr_b16 v[128:129], v24 offset:20480
ds_read_b64_tr_b16 v[130:131], v24 offset:21248
v_mfma_f32_32x32x16_bf16 v[196:211], v[88:91], v[72:75], v[196:211]
v_mfma_f32_32x32x16_bf16 v[212:227], v[88:91], v[76:79], v[212:227]
s_waitcnt lgkmcnt(8)
v_mfma_f32_32x32x16_bf16 v[132:147], v[100:103], v[92:95], v[132:147]
ds_read_b128 v[32:35], v21 offset:0
ds_read_b128 v[36:39], v21 offset:10240
v_mfma_f32_32x32x16_bf16 v[148:163], v[100:103], v[96:99], v[148:163]
ds_read_b64_tr_b16 v[40:41], v22 offset:30720
ds_read_b64_tr_b16 v[42:43], v22 offset:31488
v_mfma_f32_32x32x16_bf16 v[164:179], v[104:107], v[92:95], v[164:179]
ds_read_b64_tr_b16 v[44:45], v23 offset:30720
ds_read_b64_tr_b16 v[46:47], v23 offset:31488
v_mfma_f32_32x32x16_bf16 v[180:195], v[104:107], v[96:99], v[180:195]
ds_read_b64_tr_b16 v[48:49], v24 offset:30720
ds_read_b64_tr_b16 v[50:51], v24 offset:31488
v_mfma_f32_32x32x16_bf16 v[196:211], v[108:111], v[92:95], v[196:211]
v_mfma_f32_32x32x16_bf16 v[212:227], v[108:111], v[96:99], v[212:227]
s_waitcnt lgkmcnt(8)
v_mfma_f32_32x32x16_bf16 v[132:147], v[120:123], v[112:115], v[132:147]
v_mfma_f32_32x32x16_bf16 v[148:163], v[120:123], v[116:119], v[148:163]
v_mfma_f32_32x32x16_bf16 v[164:179], v[124:127], v[112:115], v[164:179]
v_mfma_f32_32x32x16_bf16 v[180:195], v[124:127], v[116:119], v[180:195]
v_mfma_f32_32x32x16_bf16 v[196:211], v[128:131], v[112:115], v[196:211]
v_mfma_f32_32x32x16_bf16 v[212:227], v[128:131], v[116:119], v[212:227]
s_waitcnt lgkmcnt(0)
v_subrev_u32 v18, 122880, v18
v_subrev_u32 v19, 122880, v19
v_subrev_u32 v20, 122880, v20
v_subrev_u32 v21, 122880, v21
v_subrev_u32 v22, 122880, v22
v_subrev_u32 v23, 122880, v23
v_subrev_u32 v24, 122880, v24
s_barrier
v_mfma_f32_32x32x16_bf16 v[132:147], v[40:43], v[32:35], v[132:147]
ds_read_b128 v[52:55], v18 offset:0
ds_read_b128 v[56:59], v18 offset:10240
ds_read_b64_tr_b16 v[60:61], v22 offset:0
v_mfma_f32_32x32x16_bf16 v[148:163], v[40:43], v[36:39], v[148:163]
ds_read_b64_tr_b16 v[62:63], v22 offset:768
ds_read_b64_tr_b16 v[64:65], v23 offset:0
ds_read_b64_tr_b16 v[66:67], v23 offset:768
v_mfma_f32_32x32x16_bf16 v[164:179], v[44:47], v[32:35], v[164:179]
ds_read_b64_tr_b16 v[68:69], v24 offset:0
ds_read_b64_tr_b16 v[70:71], v24 offset:768
ds_read_b128 v[72:75], v19 offset:0
v_mfma_f32_32x32x16_bf16 v[180:195], v[44:47], v[36:39], v[180:195]
ds_read_b128 v[76:79], v19 offset:10240
ds_read_b64_tr_b16 v[80:81], v22 offset:10240
ds_read_b64_tr_b16 v[82:83], v22 offset:11008
v_mfma_f32_32x32x16_bf16 v[196:211], v[48:51], v[32:35], v[196:211]
ds_read_b64_tr_b16 v[84:85], v23 offset:10240
ds_read_b64_tr_b16 v[86:87], v23 offset:11008
ds_read_b64_tr_b16 v[88:89], v24 offset:10240
v_mfma_f32_32x32x16_bf16 v[212:227], v[48:51], v[36:39], v[212:227]
ds_read_b64_tr_b16 v[90:91], v24 offset:11008
s_waitcnt lgkmcnt(8)
v_mfma_f32_32x32x16_bf16 v[132:147], v[60:63], v[52:55], v[132:147]
ds_read_b128 v[92:95], v20 offset:0
ds_read_b128 v[96:99], v20 offset:10240
v_mfma_f32_32x32x16_bf16 v[148:163], v[60:63], v[56:59], v[148:163]
ds_read_b64_tr_b16 v[100:101], v22 offset:20480
ds_read_b64_tr_b16 v[102:103], v22 offset:21248
v_mfma_f32_32x32x16_bf16 v[164:179], v[64:67], v[52:55], v[164:179]
ds_read_b64_tr_b16 v[104:105], v23 offset:20480
ds_read_b64_tr_b16 v[106:107], v23 offset:21248
v_mfma_f32_32x32x16_bf16 v[180:195], v[64:67], v[56:59], v[180:195]
ds_read_b64_tr_b16 v[108:109], v24 offset:20480
ds_read_b64_tr_b16 v[110:111], v24 offset:21248
v_mfma_f32_32x32x16_bf16 v[196:211], v[68:71], v[52:55], v[196:211]
v_mfma_f32_32x32x16_bf16 v[212:227], v[68:71], v[56:59], v[212:227]
s_waitcnt lgkmcnt(8)
v_mfma_f32_32x32x16_bf16 v[132:147], v[80:83], v[72:75], v[132:147]
ds_read_b128 v[112:115], v21 offset:0
ds_read_b128 v[116:119], v21 offset:10240
v_mfma_f32_32x32x16_bf16 v[148:163], v[80:83], v[76:79], v[148:163]
ds_read_b64_tr_b16 v[120:121], v22 offset:30720
ds_read_b64_tr_b16 v[122:123], v22 offset:31488
v_mfma_f32_32x32x16_bf16 v[164:179], v[84:87], v[72:75], v[164:179]
ds_read_b64_tr_b16 v[124:125], v23 offset:30720
ds_read_b64_tr_b16 v[126:127], v23 offset:31488
v_mfma_f32_32x32x16_bf16 v[180:195], v[84:87], v[76:79], v[180:195]
ds_read_b64_tr_b16 v[128:129], v24 offset:30720
ds_read_b64_tr_b16 v[130:131], v24 offset:31488
v_mfma_f32_32x32x16_bf16 v[196:211], v[88:91], v[72:75], v[196:211]
v_mfma_f32_32x32x16_bf16 v[212:227], v[88:91], v[76:79], v[212:227]
s_waitcnt lgkmcnt(8)
v_mfma_f32_32x32x16_bf16 v[132:147], v[100:103], v[92:95], v[132:147]
v_mfma_f32_32x32x16_bf16 v[148:163], v[100:103], v[96:99], v[148:163]
v_mfma_f32_32x32x16_bf16 v[164:179], v[104:107], v[92:95], v[164:179]
v_mfma_f32_32x32x16_bf16 v[180:195], v[104:107], v[96:99], v[180:195]
v_mfma_f32_32x32x16_bf16 v[196:211], v[108:111], v[92:95], v[196:211]
v_mfma_f32_32x32x16_bf16 v[212:227], v[108:111], v[96:99], v[212:227]
s_waitcnt lgkmcnt(0)
v_add_u32 v18, 40960, v18
v_add_u32 v19, 40960, v19
v_add_u32 v20, 40960, v20
v_add_u32 v21, 40960, v21
v_add_u32 v22, 40960, v22
v_add_u32 v23, 40960, v23
v_add_u32 v24, 40960, v24
s_barrier
s_mov_b32 s50, 200000
s_waitcnt vmcnt(0)
NW1_CHK:
v_readfirstlane_b32 s49, v31
s_cmp_lg_u32 s49, 0
s_cbranch_scc1 NW1_OK
s_sleep 2
buffer_load_dwordx2 v[30:31], v17, s[20:23], 0 offen sc1
s_sub_u32 s50, s50, 1
s_waitcnt vmcnt(0)
s_cmp_lg_u32 s50, 0
s_cbranch_scc1 NW1_CHK
NW1_OK:
s_cmp_lg_u32 s75, 0
s_cbranch_scc1 NW1_DONE
v_or_b32 v4, s71, v30
v_mov_b32 v5, v31
s_mov_b64 s[48:49], exec
s_mov_b64 exec, 1
buffer_store_dwordx2 v[4:5], v17, s[24:27], s70 offen
s_mov_b64 exec, s[48:49]
NW1_DONE:
v_mfma_f32_32x32x16_bf16 v[132:147], v[120:123], v[112:115], v[132:147]
ds_read_b128 v[32:35], v18 offset:0
ds_read_b128 v[36:39], v18 offset:10240
ds_read_b64_tr_b16 v[40:41], v22 offset:0
v_mfma_f32_32x32x16_bf16 v[148:163], v[120:123], v[116:119], v[148:163]
ds_read_b64_tr_b16 v[42:43], v22 offset:768
ds_read_b64_tr_b16 v[44:45], v23 offset:0
ds_read_b64_tr_b16 v[46:47], v23 offset:768
v_mfma_f32_32x32x16_bf16 v[164:179], v[124:127], v[112:115], v[164:179]
ds_read_b64_tr_b16 v[48:49], v24 offset:0
ds_read_b64_tr_b16 v[50:51], v24 offset:768
ds_read_b128 v[52:55], v19 offset:0
v_mfma_f32_32x32x16_bf16 v[180:195], v[124:127], v[116:119], v[180:195]
ds_read_b128 v[56:59], v19 offset:10240
ds_read_b64_tr_b16 v[60:61], v22 offset:10240
ds_read_b64_tr_b16 v[62:63], v22 offset:11008
v_mfma_f32_32x32x16_bf16 v[196:211], v[128:131], v[112:115], v[196:211]
ds_read_b64_tr_b16 v[64:65], v23 offset:10240
ds_read_b64_tr_b16 v[66:67], v23 offset:11008
ds_read_b64_tr_b16 v[68:69], v24 offset:10240
v_mfma_f32_32x32x16_bf16 v[212:227], v[128:131], v[116:119], v[212:227]
ds_read_b64_tr_b16 v[70:71], v24 offset:11008
s_waitcnt lgkmcnt(8)
v_mfma_f32_32x32x16_bf16 v[132:147], v[40:43], v[32:35], v[132:147]
ds_read_b128 v[72:75], v20 offset:0
ds_read_b128 v[76:79], v20 offset:10240
v_mfma_f32_32x32x16_bf16 v[148:163], v[40:43], v[36:39], v[148:163]
ds_read_b64_tr_b16 v[80:81], v22 offset:20480
ds_read_b64_tr_b16 v[82:83], v22 offset:21248
v_mfma_f32_32x32x16_bf16 v[164:179], v[44:47], v[32:35], v[164:179]
ds_read_b64_tr_b16 v[84:85], v23 offset:20480
ds_read_b64_tr_b16 v[86:87], v23 offset:21248
v_mfma_f32_32x32x16_bf16 v[180:195], v[44:47], v[36:39], v[180:195]
ds_read_b64_tr_b16 v[88:89], v24 offset:20480
ds_read_b64_tr_b16 v[90:91], v24 offset:21248
v_mfma_f32_32x32x16_bf16 v[196:211], v[48:51], v[32:35], v[196:211]
v_mfma_f32_32x32x16_bf16 v[212:227], v[48:51], v[36:39], v[212:227]
s_waitcnt lgkmcnt(8)
v_mfma_f32_32x32x16_bf16 v[132:147], v[60:63], v[52:55], v[132:147]
ds_read_b128 v[92:95], v21 offset:0
ds_read_b128 v[96:99], v21 offset:10240
v_mfma_f32_32x32x16_bf16 v[148:163], v[60:63], v[56:59], v[148:163]
ds_read_b64_tr_b16 v[100:101], v22 offset:30720
ds_read_b64_tr_b16 v[102:103], v22 offset:31488
v_mfma_f32_32x32x16_bf16 v[164:179], v[64:67], v[52:55], v[164:179]
ds_read_b64_tr_b16 v[104:105], v23 offset:30720
ds_read_b64_tr_b16 v[106:107], v23 offset:31488
v_mfma_f32_32x32x16_bf16 v[180:195], v[64:67], v[56:59], v[180:195]
ds_read_b64_tr_b16 v[108:109], v24 offset:30720
ds_read_b64_tr_b16 v[110:111], v24 offset:31488
v_mfma_f32_32x32x16_bf16 v[196:211], v[68:71], v[52:55], v[196:211]
v_mfma_f32_32x32x16_bf16 v[212:227], v[68:71], v[56:59], v[212:227]
s_waitcnt lgkmcnt(8)
v_mfma_f32_32x32x16_bf16 v[132:147], v[80:83], v[72:75], v[132:147]
v_mfma_f32_32x32x16_bf16 v[148:163], v[80:83], v[76:79], v[148:163]
v_mfma_f32_32x32x16_bf16 v[164:179], v[84:87], v[72:75], v[164:179]
v_mfma_f32_32x32x16_bf16 v[180:195], v[84:87], v[76:79], v[180:195]
v_mfma_f32_32x32x16_bf16 v[196:211], v[88:91], v[72:75], v[196:211]
v_mfma_f32_32x32x16_bf16 v[212:227], v[88:91], v[76:79], v[212:227]
s_waitcnt lgkmcnt(0)
v_add_u32 v18, 40960, v18
v_add_u32 v19, 40960, v19
v_add_u32 v20, 40960, v20
v_add_u32 v21, 40960, v21
v_add_u32 v22, 40960, v22
v_add_u32 v23, 40960, v23
v_add_u32 v24, 40960, v24
s_barrier
v_mfma_f32_32x32x16_bf16 v[132:147], v[100:103], v[92:95], v[132:147]
ds_read_b128 v[112:115], v18 offset:0
ds_read_b128 v[116:119], v18 offset:10240
ds_read_b64_tr_b16 v[120:121], v22 offset:0
v_mfma_f32_32x32x16_bf16 v[148:163], v[100:103], v[96:99], v[148:163]
ds_read_b64_tr_b16 v[122:123], v22 offset:768
ds_read_b64_tr_b16 v[124:125], v23 offset:0
ds_read_b64_tr_b16 v[126:127], v23 offset:768
v_mfma_f32_32x32x16_bf16 v[164:179], v[104:107], v[92:95], v[164:179]
ds_read_b64_tr_b16 v[128:129], v24 offset:0
ds_read_b64_tr_b16 v[130:131], v24 offset:768
ds_read_b128 v[32:35], v19 offset:0
v_mfma_f32_32x32x16_bf16 v[180:195], v[104:107], v[96:99], v[180:195]
ds_read_b128 v[36:39], v19 offset:10240
ds_read_b64_tr_b16 v[40:41], v22 offset:10240
ds_read_b64_tr_b16 v[42:43], v22 offset:11008
v_mfma_f32_32x32x16_bf16 v[196:211], v[108:111], v[92:95], v[196:211]
ds_read_b64_tr_b16 v[44:45], v23 offset:10240
ds_read_b64_tr_b16 v[46:47], v23 offset:11008
ds_read_b64_tr_b16 v[48:49], v24 offset:10240
v_mfma_f32_32x32x16_bf16 v[212:227], v[108:111], v[96:99], v[212:227]
ds_read_b64_tr_b16 v[50:51], v24 offset:11008
s_waitcnt lgkmcnt(8)
v_mfma_f32_32x32x16_bf16 v[132:147], v[120:123], v[112:115], v[132:147]
ds_read_b128 v[52:55], v20 offset:0
ds_read_b128 v[56:59], v20 offset:10240
v_mfma_f32_32x32x16_bf16 v[148:163], v[120:123], v[116:119], v[148:163]
ds_read_b64_tr_b16 v[60:61], v22 offset:20480
ds_read_b64_tr_b16 v[62:63], v22 offset:21248
v_mfma_f32_32x32x16_bf16 v[164:179], v[124:127], v[112:115], v[164:179]
ds_read_b64_tr_b16 v[64:65], v23 offset:20480
ds_read_b64_tr_b16 v[66:67], v23 offset:21248
v_mfma_f32_32x32x16_bf16 v[180:195], v[124:127], v[116:119], v[180:195]
ds_read_b64_tr_b16 v[68:69], v24 offset:20480
ds_read_b64_tr_b16 v[70:71], v24 offset:21248
v_mfma_f32_32x32x16_bf16 v[196:211], v[128:131], v[112:115], v[196:211]
v_mfma_f32_32x32x16_bf16 v[212:227], v[128:131], v[116:119], v[212:227]
s_waitcnt lgkmcnt(8)
v_mfma_f32_32x32x16_bf16 v[132:147], v[40:43], v[32:35], v[132:147]
ds_read_b128 v[72:75], v21 offset:0
ds_read_b128 v[76:79], v21 offset:10240
v_mfma_f32_32x32x16_bf16 v[148:163], v[40:43], v[36:39], v[148:163]
ds_read_b64_tr_b16 v[80:81], v22 offset:30720
ds_read_b64_tr_b16 v[82:83], v22 offset:31488
v_mfma_f32_32x32x16_bf16 v[164:179], v[44:47], v[32:35], v[164:179]
ds_read_b64_tr_b16 v[84:85], v23 offset:30720
ds_read_b64_tr_b16 v[86:87], v23 offset:31488
v_mfma_f32_32x32x16_bf16 v[180:195], v[44:47], v[36:39], v[180:195]
ds_read_b64_tr_b16 v[88:89], v24 offset:30720
ds_read_b64_tr_b16 v[90:91], v24 offset:31488
v_mfma_f32_32x32x16_bf16 v[196:211], v[48:51], v[32:35], v[196:211]
v_mfma_f32_32x32x16_bf16 v[212:227], v[48:51], v[36:39], v[212:227]
s_waitcnt lgkmcnt(8)
v_mfma_f32_32x32x16_bf16 v[132:147], v[60:63], v[52:55], v[132:147]
v_mfma_f32_32x32x16_bf16 v[148:163], v[60:63], v[56:59], v[148:163]
v_mfma_f32_32x32x16_bf16 v[164:179], v[64:67], v[52:55], v[164:179]
v_mfma_f32_32x32x16_bf16 v[180:195], v[64:67], v[56:59], v[180:195]
v_mfma_f32_32x32x16_bf16 v[196:211], v[68:71], v[52:55], v[196:211]
v_mfma_f32_32x32x16_bf16 v[212:227], v[68:71], v[56:59], v[212:227]
s_waitcnt lgkmcnt(0)
v_add_u32 v18, 40960, v18
v_add_u32 v19, 40960, v19
v_add_u32 v20, 40960, v20
v_add_u32 v21, 40960, v21
v_add_u32 v22, 40960, v22
v_add_u32 v23, 40960, v23
v_add_u32 v24, 40960, v24
s_barrier
v_mfma_f32_32x32x16_bf16 v[132:147], v[80:83], v[72:75], v[132:147]
ds_read_b128 v[92:95], v18 offset:0
ds_read_b64_tr_b16 v[100:101], v22 offset:0
ds_read_b64_tr_b16 v[102:103], v22 offset:768
ds_read_b128 v[112:115], v19 offset:0
v_mfma_f32_32x32x16_bf16 v[148:163], v[80:83], v[76:79], v[148:163]
ds_read_b64_tr_b16 v[120:121], v22 offset:10240
ds_read_b64_tr_b16 v[122:123], v22 offset:11008
ds_read_b128 v[32:35], v20 offset:0
ds_read_b64_tr_b16 v[40:41], v22 offset:20480
v_mfma_f32_32x32x16_bf16 v[164:179], v[84:87], v[72:75], v[164:179]
ds_read_b64_tr_b16 v[42:43], v22 offset:21248
ds_read_b128 v[52:55], v21 offset:0
ds_read_b64_tr_b16 v[60:61], v22 offset:30720
ds_read_b64_tr_b16 v[62:63], v22 offset:31488
v_mfma_f32_32x32x16_bf16 v[180:195], v[84:87], v[76:79], v[180:195]
ds_read_b128 v[96:99], v18 offset:10240
ds_read_b128 v[116:119], v19 offset:10240
ds_read_b128 v[36:39], v20 offset:10240
ds_read_b128 v[56:59], v21 offset:10240
v_mfma_f32_32x32x16_bf16 v[196:211], v[88:91], v[72:75], v[196:211]
v_mfma_f32_32x32x16_bf16 v[212:227], v[88:91], v[76:79], v[212:227]
s_waitcnt lgkmcnt(4)
v_mfma_f32_32x32x16_bf16 v[132:147], v[100:103], v[92:95], v[132:147]
ds_read_b64_tr_b16 v[104:105], v23 offset:0
ds_read_b64_tr_b16 v[106:107], v23 offset:768
v_mfma_f32_32x32x16_bf16 v[132:147], v[120:123], v[112:115], v[132:147]
ds_read_b64_tr_b16 v[124:125], v23 offset:10240
ds_read_b64_tr_b16 v[126:127], v23 offset:11008
v_mfma_f32_32x32x16_bf16 v[132:147], v[40:43], v[32:35], v[132:147]
ds_read_b64_tr_b16 v[44:45], v23 offset:20480
ds_read_b64_tr_b16 v[46:47], v23 offset:21248
v_mfma_f32_32x32x16_bf16 v[132:147], v[60:63], v[52:55], v[132:147]
ds_read_b64_tr_b16 v[64:65], v23 offset:30720
ds_read_b64_tr_b16 v[66:67], v23 offset:31488
s_waitcnt lgkmcnt(8)
v_mfma_f32_32x32x16_bf16 v[148:163], v[100:103], v[96:99], v[148:163]
ds_read_b64_tr_b16 v[108:109], v24 offset:0
ds_read_b64_tr_b16 v[110:111], v24 offset:768
ds_read_b64_tr_b16 v[128:129], v24 offset:10240
ds_read_b64_tr_b16 v[130:131], v24 offset:11008
ds_read_b64_tr_b16 v[48:49], v24 offset:20480
ds_read_b64_tr_b16 v[50:51], v24 offset:21248
ds_read_b64_tr_b16 v[68:69], v24 offset:30720
ds_read_b64_tr_b16 v[70:71], v24 offset:31488
v_mfma_f32_32x32x16_bf16 v[148:163], v[120:123], v[116:119], v[148:163]
buffer_load_dwordx2 v[4:5], v1, s[24:27], 0 offen sc1
buffer_load_dword v3, v15, s[24:27], 0 offen sc1
v_pk_mul_f32 v[228:229], v[132:133], v[132:133]
v_pk_mul_f32 v[230:231], v[134:135], v[134:135]
v_pk_mul_f32 v[232:233], v[136:137], v[136:137]
v_pk_mul_f32 v[234:235], v[138:139], v[138:139]
v_pk_fma_f32 v[228:229], v[228:229], s[54:55], v[26:27]
v_pk_fma_f32 v[230:231], v[230:231], s[54:55], v[26:27]
v_pk_fma_f32 v[232:233], v[232:233], s[54:55], v[26:27]
v_pk_fma_f32 v[234:235], v[234:235], s[54:55], v[26:27]
v_pk_mul_f32 v[228:229], v[228:229], v[132:133]
v_pk_mul_f32 v[230:231], v[230:231], v[134:135]
v_pk_mul_f32 v[232:233], v[232:233], v[136:137]
v_pk_mul_f32 v[234:235], v[234:235], v[138:139]
v_mfma_f32_32x32x16_bf16 v[148:163], v[40:43], v[36:39], v[148:163]
v_exp_f32 v228, v228
v_exp_f32 v230, v230
v_exp_f32 v232, v232
v_exp_f32 v234, v234
v_mfma_f32_32x32x16_bf16 v[148:163], v[60:63], v[56:59], v[148:163]
v_exp_f32 v229, v229
v_exp_f32 v231, v231
v_exp_f32 v233, v233
v_exp_f32 v235, v235
v_pk_add_f32 v[228:229], v[228:229], v[28:29]
v_pk_add_f32 v[230:231], v[230:231], v[28:29]
v_pk_add_f32 v[232:233], v[232:233], v[28:29]
v_pk_add_f32 v[234:235], v[234:235], v[28:29]
s_waitcnt lgkmcnt(0)
s_barrier
v_mfma_f32_32x32x16_bf16 v[164:179], v[104:107], v[92:95], v[164:179]
v_rcp_f32 v228, v228
v_rcp_f32 v230, v230
v_rcp_f32 v232, v232
v_rcp_f32 v234, v234
v_mfma_f32_32x32x16_bf16 v[164:179], v[124:127], v[112:115], v[164:179]
v_rcp_f32 v229, v229
v_rcp_f32 v231, v231
v_rcp_f32 v233, v233
v_rcp_f32 v235, v235
v_pk_mul_f32 v[228:229], v[228:229], v[132:133]
v_pk_mul_f32 v[230:231], v[230:231], v[134:135]
v_pk_mul_f32 v[232:233], v[232:233], v[136:137]
v_pk_mul_f32 v[234:235], v[234:235], v[138:139]
v_pk_mul_f32 v[228:229], v[228:229], v[140:141]
v_pk_mul_f32 v[230:231], v[230:231], v[142:143]
v_pk_mul_f32 v[232:233], v[232:233], v[144:145]
v_pk_mul_f32 v[234:235], v[234:235], v[146:147]
v_cvt_pk_bf16_f32 v236, v228, v229
v_cvt_pk_bf16_f32 v237, v230, v231
v_cvt_pk_bf16_f32 v238, v232, v233
v_cvt_pk_bf16_f32 v239, v234, v235
v_pk_mul_f32 v[228:229], v[148:149], v[148:149]
v_pk_mul_f32 v[230:231], v[150:151], v[150:151]
v_pk_mul_f32 v[232:233], v[152:153], v[152:153]
v_pk_mul_f32 v[234:235], v[154:155], v[154:155]
v_pk_fma_f32 v[228:229], v[228:229], s[54:55], v[26:27]
v_pk_fma_f32 v[230:231], v[230:231], s[54:55], v[26:27]
v_pk_fma_f32 v[232:233], v[232:233], s[54:55], v[26:27]
v_pk_fma_f32 v[234:235], v[234:235], s[54:55], v[26:27]
v_pk_mul_f32 v[228:229], v[228:229], v[148:149]
v_pk_mul_f32 v[230:231], v[230:231], v[150:151]
v_pk_mul_f32 v[232:233], v[232:233], v[152:153]
v_pk_mul_f32 v[234:235], v[234:235], v[154:155]
v_mfma_f32_32x32x16_bf16 v[164:179], v[44:47], v[32:35], v[164:179]
v_exp_f32 v228, v228
v_exp_f32 v230, v230
v_exp_f32 v232, v232
v_exp_f32 v234, v234
v_mfma_f32_32x32x16_bf16 v[164:179], v[64:67], v[52:55], v[164:179]
v_exp_f32 v229, v229
v_exp_f32 v231, v231
v_exp_f32 v233, v233
v_exp_f32 v235, v235
v_pk_add_f32 v[228:229], v[228:229], v[28:29]
v_pk_add_f32 v[230:231], v[230:231], v[28:29]
v_pk_add_f32 v[232:233], v[232:233], v[28:29]
v_pk_add_f32 v[234:235], v[234:235], v[28:29]
v_mfma_f32_32x32x16_bf16 v[180:195], v[104:107], v[96:99], v[180:195]
v_rcp_f32 v228, v228
v_rcp_f32 v230, v230
v_rcp_f32 v232, v232
v_rcp_f32 v234, v234
v_mfma_f32_32x32x16_bf16 v[180:195], v[124:127], v[116:119], v[180:195]
v_rcp_f32 v229, v229
v_rcp_f32 v231, v231
v_rcp_f32 v233, v233
v_rcp_f32 v235, v235
v_pk_mul_f32 v[228:229], v[228:229], v[148:149]
v_pk_mul_f32 v[230:231], v[230:231], v[150:151]
v_pk_mul_f32 v[232:233], v[232:233], v[152:153]
v_pk_mul_f32 v[234:235], v[234:235], v[154:155]
v_pk_mul_f32 v[228:229], v[228:229], v[156:157]
v_pk_mul_f32 v[230:231], v[230:231], v[158:159]
v_pk_mul_f32 v[232:233], v[232:233], v[160:161]
v_pk_mul_f32 v[234:235], v[234:235], v[162:163]
v_cvt_pk_bf16_f32 v240, v228, v229
v_cvt_pk_bf16_f32 v241, v230, v231
v_cvt_pk_bf16_f32 v242, v232, v233
v_cvt_pk_bf16_f32 v243, v234, v235
buffer_store_dwordx4 v[236:239], v25, s[32:35], s28 offen sc1
buffer_store_dwordx4 v[240:243], v25, s[32:35], s29 offen sc1
v_pk_mul_f32 v[228:229], v[164:165], v[164:165]
v_pk_mul_f32 v[230:231], v[166:167], v[166:167]
v_pk_mul_f32 v[232:233], v[168:169], v[168:169]
v_pk_mul_f32 v[234:235], v[170:171], v[170:171]
v_pk_fma_f32 v[228:229], v[228:229], s[54:55], v[26:27]
v_pk_fma_f32 v[230:231], v[230:231], s[54:55], v[26:27]
v_pk_fma_f32 v[232:233], v[232:233], s[54:55], v[26:27]
v_pk_fma_f32 v[234:235], v[234:235], s[54:55], v[26:27]
v_pk_mul_f32 v[228:229], v[228:229], v[164:165]
v_pk_mul_f32 v[230:231], v[230:231], v[166:167]
v_pk_mul_f32 v[232:233], v[232:233], v[168:169]
v_pk_mul_f32 v[234:235], v[234:235], v[170:171]
v_mfma_f32_32x32x16_bf16 v[180:195], v[44:47], v[36:39], v[180:195]
v_exp_f32 v228, v228
v_exp_f32 v230, v230
v_exp_f32 v232, v232
v_exp_f32 v234, v234
v_mfma_f32_32x32x16_bf16 v[180:195], v[64:67], v[56:59], v[180:195]
v_exp_f32 v229, v229
v_exp_f32 v231, v231
v_exp_f32 v233, v233
v_exp_f32 v235, v235
v_pk_add_f32 v[228:229], v[228:229], v[28:29]
v_pk_add_f32 v[230:231], v[230:231], v[28:29]
v_pk_add_f32 v[232:233], v[232:233], v[28:29]
v_pk_add_f32 v[234:235], v[234:235], v[28:29]
v_mfma_f32_32x32x16_bf16 v[196:211], v[108:111], v[92:95], v[196:211]
v_rcp_f32 v228, v228
v_rcp_f32 v230, v230
v_rcp_f32 v232, v232
v_rcp_f32 v234, v234
v_mfma_f32_32x32x16_bf16 v[196:211], v[128:131], v[112:115], v[196:211]
v_rcp_f32 v229, v229
v_rcp_f32 v231, v231
v_rcp_f32 v233, v233
v_rcp_f32 v235, v235
v_pk_mul_f32 v[228:229], v[228:229], v[164:165]
v_pk_mul_f32 v[230:231], v[230:231], v[166:167]
v_pk_mul_f32 v[232:233], v[232:233], v[168:169]
v_pk_mul_f32 v[234:235], v[234:235], v[170:171]
v_pk_mul_f32 v[228:229], v[228:229], v[172:173]
v_pk_mul_f32 v[230:231], v[230:231], v[174:175]
v_pk_mul_f32 v[232:233], v[232:233], v[176:177]
v_pk_mul_f32 v[234:235], v[234:235], v[178:179]
v_cvt_pk_bf16_f32 v244, v228, v229
v_cvt_pk_bf16_f32 v245, v230, v231
v_cvt_pk_bf16_f32 v246, v232, v233
v_cvt_pk_bf16_f32 v247, v234, v235
buffer_store_dwordx4 v[244:247], v25, s[32:35], s30 offen sc1
v_pk_mul_f32 v[228:229], v[180:181], v[180:181]
v_pk_mul_f32 v[230:231], v[182:183], v[182:183]
v_pk_mul_f32 v[232:233], v[184:185], v[184:185]
v_pk_mul_f32 v[234:235], v[186:187], v[186:187]
v_pk_fma_f32 v[228:229], v[228:229], s[54:55], v[26:27]
v_pk_fma_f32 v[230:231], v[230:231], s[54:55], v[26:27]
v_pk_fma_f32 v[232:233], v[232:233], s[54:55], v[26:27]
v_pk_fma_f32 v[234:235], v[234:235], s[54:55], v[26:27]
v_pk_mul_f32 v[228:229], v[228:229], v[180:181]
v_pk_mul_f32 v[230:231], v[230:231], v[182:183]
v_pk_mul_f32 v[232:233], v[232:233], v[184:185]
v_pk_mul_f32 v[234:235], v[234:235], v[186:187]
v_mfma_f32_32x32x16_bf16 v[196:211], v[48:51], v[32:35], v[196:211]
v_exp_f32 v228, v228
v_exp_f32 v230, v230
v_exp_f32 v232, v232
v_exp_f32 v234, v234
v_mfma_f32_32x32x16_bf16 v[196:211], v[68:71], v[52:55], v[196:211]
v_exp_f32 v229, v229
v_exp_f32 v231, v231
v_exp_f32 v233, v233
v_exp_f32 v235, v235
v_pk_add_f32 v[228:229], v[228:229], v[28:29]
v_pk_add_f32 v[230:231], v[230:231], v[28:29]
v_pk_add_f32 v[232:233], v[232:233], v[28:29]
v_pk_add_f32 v[234:235], v[234:235], v[28:29]
v_mfma_f32_32x32x16_bf16 v[212:227], v[108:111], v[96:99], v[212:227]
v_rcp_f32 v228, v228
v_rcp_f32 v230, v230
v_rcp_f32 v232, v232
v_rcp_f32 v234, v234
v_mfma_f32_32x32x16_bf16 v[212:227], v[128:131], v[116:119], v[212:227]
v_rcp_f32 v229, v229
v_rcp_f32 v231, v231
v_rcp_f32 v233, v233
v_rcp_f32 v235, v235
v_pk_mul_f32 v[228:229], v[228:229], v[180:181]
v_pk_mul_f32 v[230:231], v[230:231], v[182:183]
v_pk_mul_f32 v[232:233], v[232:233], v[184:185]
v_pk_mul_f32 v[234:235], v[234:235], v[186:187]
v_pk_mul_f32 v[228:229], v[228:229], v[188:189]
v_pk_mul_f32 v[230:231], v[230:231], v[190:191]
v_pk_mul_f32 v[232:233], v[232:233], v[192:193]
v_pk_mul_f32 v[234:235], v[234:235], v[194:195]
v_cvt_pk_bf16_f32 v248, v228, v229
v_cvt_pk_bf16_f32 v249, v230, v231
v_cvt_pk_bf16_f32 v250, v232, v233
v_cvt_pk_bf16_f32 v251, v234, v235
buffer_store_dwordx4 v[248:251], v25, s[32:35], s31 offen sc1
v_pk_mul_f32 v[228:229], v[196:197], v[196:197]
v_pk_mul_f32 v[230:231], v[198:199], v[198:199]
v_pk_mul_f32 v[232:233], v[200:201], v[200:201]
v_pk_mul_f32 v[234:235], v[202:203], v[202:203]
v_pk_fma_f32 v[228:229], v[228:229], s[54:55], v[26:27]
v_pk_fma_f32 v[230:231], v[230:231], s[54:55], v[26:27]
v_pk_fma_f32 v[232:233], v[232:233], s[54:55], v[26:27]
v_pk_fma_f32 v[234:235], v[234:235], s[54:55], v[26:27]
v_pk_mul_f32 v[228:229], v[228:229], v[196:197]
v_pk_mul_f32 v[230:231], v[230:231], v[198:199]
v_pk_mul_f32 v[232:233], v[232:233], v[200:201]
v_pk_mul_f32 v[234:235], v[234:235], v[202:203]
v_mfma_f32_32x32x16_bf16 v[212:227], v[48:51], v[36:39], v[212:227]
v_exp_f32 v228, v228
v_exp_f32 v230, v230
v_exp_f32 v232, v232
v_exp_f32 v234, v234
v_mfma_f32_32x32x16_bf16 v[212:227], v[68:71], v[56:59], v[212:227]
v_exp_f32 v229, v229
v_exp_f32 v231, v231
v_exp_f32 v233, v233
v_exp_f32 v235, v235
v_pk_add_f32 v[228:229], v[228:229], v[28:29]
v_pk_add_f32 v[230:231], v[230:231], v[28:29]
v_pk_add_f32 v[232:233], v[232:233], v[28:29]
v_pk_add_f32 v[234:235], v[234:235], v[28:29]
v_rcp_f32 v228, v228
v_rcp_f32 v230, v230
v_rcp_f32 v232, v232
v_rcp_f32 v234, v234
v_rcp_f32 v229, v229
v_rcp_f32 v231, v231
v_rcp_f32 v233, v233
v_rcp_f32 v235, v235
v_pk_mul_f32 v[228:229], v[228:229], v[196:197]
v_pk_mul_f32 v[230:231], v[230:231], v[198:199]
v_pk_mul_f32 v[232:233], v[232:233], v[200:201]
v_pk_mul_f32 v[234:235], v[234:235], v[202:203]
v_pk_mul_f32 v[228:229], v[228:229], v[204:205]
v_pk_mul_f32 v[230:231], v[230:231], v[206:207]
v_pk_mul_f32 v[232:233], v[232:233], v[208:209]
v_pk_mul_f32 v[234:235], v[234:235], v[210:211]
v_cvt_pk_bf16_f32 v252, v228, v229
v_cvt_pk_bf16_f32 v253, v230, v231
v_cvt_pk_bf16_f32 v254, v232, v233
v_cvt_pk_bf16_f32 v255, v234, v235
buffer_store_dwordx4 v[252:255], v25, s[32:35], s36 offen sc1
v_pk_mul_f32 v[228:229], v[212:213], v[212:213]
v_pk_mul_f32 v[230:231], v[214:215], v[214:215]
v_pk_mul_f32 v[232:233], v[216:217], v[216:217]
v_pk_mul_f32 v[234:235], v[218:219], v[218:219]
v_pk_fma_f32 v[228:229], v[228:229], s[54:55], v[26:27]
v_pk_fma_f32 v[230:231], v[230:231], s[54:55], v[26:27]
v_pk_fma_f32 v[232:233], v[232:233], s[54:55], v[26:27]
v_pk_fma_f32 v[234:235], v[234:235], s[54:55], v[26:27]
v_pk_mul_f32 v[228:229], v[228:229], v[212:213]
v_pk_mul_f32 v[230:231], v[230:231], v[214:215]
v_pk_mul_f32 v[232:233], v[232:233], v[216:217]
v_pk_mul_f32 v[234:235], v[234:235], v[218:219]
v_exp_f32 v228, v228
v_exp_f32 v230, v230
v_exp_f32 v232, v232
v_exp_f32 v234, v234
v_exp_f32 v229, v229
v_exp_f32 v231, v231
v_exp_f32 v233, v233
v_exp_f32 v235, v235
v_pk_add_f32 v[228:229], v[228:229], v[28:29]
v_pk_add_f32 v[230:231], v[230:231], v[28:29]
v_pk_add_f32 v[232:233], v[232:233], v[28:29]
v_pk_add_f32 v[234:235], v[234:235], v[28:29]
v_rcp_f32 v228, v228
v_rcp_f32 v230, v230
v_rcp_f32 v232, v232
v_rcp_f32 v234, v234
v_rcp_f32 v229, v229
v_rcp_f32 v231, v231
v_rcp_f32 v233, v233
v_rcp_f32 v235, v235
v_pk_mul_f32 v[228:229], v[228:229], v[212:213]
v_pk_mul_f32 v[230:231], v[230:231], v[214:215]
v_pk_mul_f32 v[232:233], v[232:233], v[216:217]
v_pk_mul_f32 v[234:235], v[234:235], v[218:219]
v_pk_mul_f32 v[228:229], v[228:229], v[220:221]
v_pk_mul_f32 v[230:231], v[230:231], v[222:223]
v_pk_mul_f32 v[232:233], v[232:233], v[224:225]
v_pk_mul_f32 v[234:235], v[234:235], v[226:227]
v_cvt_pk_bf16_f32 v72, v228, v229
v_cvt_pk_bf16_f32 v73, v230, v231
v_cvt_pk_bf16_f32 v74, v232, v233
v_cvt_pk_bf16_f32 v75, v234, v235
buffer_store_dwordx4 v[72:75], v25, s[32:35], s37 offen sc1
s_barrier
s_waitcnt vmcnt(6)
v_or_b32 v3, s71, v30
v_cmp_ne_u32 vcc, v4, v3
v_cmp_ne_u32 s[48:49], v5, v31
s_or_b64 vcc, vcc, s[48:49]
s_cmp_lg_u64 vcc, 0
s_cselect_b32 s74, 2, 1
s_branch C_P2
C_IDLE:
buffer_load_dwordx2 v[30:31], v17, s[20:23], 0 offen sc1
s_mov_b32 s50, 200000
s_waitcnt vmcnt(0)
NW2_CHK:
v_readfirstlane_b32 s49, v31
s_cmp_lg_u32 s49, 0
s_cbranch_scc1 NW2_OK
s_sleep 2
buffer_load_dwordx2 v[30:31], v17, s[20:23], 0 offen sc1
s_sub_u32 s50, s50, 1
s_waitcnt vmcnt(0)
s_cmp_lg_u32 s50, 0
s_cbranch_scc1 NW2_CHK
NW2_OK:
s_cmp_lg_u32 s75, 0
s_cbranch_scc1 NW2_DONE
v_or_b32 v4, s71, v30
v_mov_b32 v5, v31
s_mov_b64 s[48:49], exec
s_mov_b64 exec, 1
buffer_store_dwordx2 v[4:5], v17, s[24:27], s70 offen
s_mov_b64 exec, s[48:49]
NW2_DONE:
s_barrier
s_mov_b32 s74, 0
C_P2:
s_waitcnt vmcnt(0)
s_cmp_eq_u32 s74, 0
s_cbranch_scc1 NO_FLAG
s_mov_b64 s[48:49], exec
s_mov_b64 exec, 1
s_cmp_eq_u32 s74, 2
s_cbranch_scc1 FL_SLOW
buffer_store_dwordx2 v[30:31], v16, s[24:27], 0 offen
s_branch FL_DONE
FL_SLOW:
buffer_store_dwordx2 v[30:31], v16, s[24:27], 0 offen sc1
FL_DONE:
s_mov_b64 exec, s[48:49]
NO_FLAG:
s_mov_b32 s50, 200000
POLL:
buffer_load_dwordx2 v[4:5], v15, s[24:27], 0 offen sc1
s_sub_u32 s50, s50, 1
s_waitcnt vmcnt(0)
v_cmp_ne_u64 vcc, v[4:5], v[30:31]
s_cmp_eq_u32 s50, 0
s_cbranch_scc1 POLL_DONE
s_cbranch_vccnz POLL
POLL_DONE:
s_add_u32 s51, s60, 0
buffer_load_dwordx4 v[32:35], v25, s[32:35], s51 offen offset:0 sc1
buffer_load_dwordx4 v[36:39], v25, s[32:35], s51 offen offset:1024 sc1
buffer_load_dwordx4 v[40:43], v25, s[32:35], s51 offen offset:2048 sc1
buffer_load_dwordx4 v[44:47], v25, s[32:35], s51 offen offset:3072 sc1
s_add_u32 s51, s60, 4096
buffer_load_dwordx4 v[48:51], v25, s[32:35], s51 offen offset:0 sc1
buffer_load_dwordx4 v[52:55], v25, s[32:35], s51 offen offset:1024 sc1
buffer_load_dwordx4 v[56:59], v25, s[32:35], s51 offen offset:2048 sc1
buffer_load_dwordx4 v[60:63], v25, s[32:35], s51 offen offset:3072 sc1
s_add_u32 s51, s60, 8192
buffer_load_dwordx4 v[64:67], v25, s[32:35], s51 offen offset:0 sc1
buffer_load_dwordx4 v[68:71], v25, s[32:35], s51 offen offset:1024 sc1
s_add_u32 s51, s61, 0
buffer_load_dwordx4 v[72:75], v25, s[32:35], s51 offen offset:0 sc1
buffer_load_dwordx4 v[76:79], v25, s[32:35], s51 offen offset:1024 sc1
buffer_load_dwordx4 v[80:83], v25, s[32:35], s51 offen offset:2048 sc1
buffer_load_dwordx4 v[84:87], v25, s[32:35], s51 offen offset:3072 sc1
s_add_u32 s51, s61, 4096
buffer_load_dwordx4 v[88:91], v25, s[32:35], s51 offen offset:0 sc1
s_barrier
ds_read_b64_tr_b16 v[96:97], v8 offset:0
ds_read_b64_tr_b16 v[98:99], v8 offset:512
ds_read_b64_tr_b16 v[100:101], v11 offset:0
ds_read_b64_tr_b16 v[102:103], v11 offset:512
ds_read_b64_tr_b16 v[104:105], v8 offset:2048
ds_read_b64_tr_b16 v[106:107], v8 offset:2560
ds_read_b64_tr_b16 v[108:109], v11 offset:2048
ds_read_b64_tr_b16 v[110:111], v11 offset:2560
s_waitcnt vmcnt(14) lgkmcnt(4)
v_mfma_f32_32x32x16_bf16 v[184:199], v[96:99], v[32:35], 0
ds_read_b64_tr_b16 v[112:113], v8 offset:4096
ds_read_b64_tr_b16 v[114:115], v8 offset:4608
ds_read_b64_tr_b16 v[116:117], v11 offset:4096
ds_read_b64_tr_b16 v[118:119], v11 offset:4608
v_mfma_f32_32x32x16_bf16 v[200:215], v[100:103], v[32:35], 0
buffer_load_dwordx4 v[92:95], v25, s[32:35], s51 offen offset:1024 sc1
s_waitcnt vmcnt(14) lgkmcnt(4)
v_mfma_f32_32x32x16_bf16 v[184:199], v[104:107], v[36:39], v[184:199]
ds_read_b64_tr_b16 v[120:121], v8 offset:6144
ds_read_b64_tr_b16 v[122:123], v8 offset:6656
ds_read_b64_tr_b16 v[124:125], v11 offset:6144
ds_read_b64_tr_b16 v[126:127], v11 offset:6656
v_mfma_f32_32x32x16_bf16 v[200:215], v[108:111], v[36:39], v[200:215]
buffer_load_dwordx4 v[32:35], v25, s[32:35], s51 offen offset:2048 sc1
s_waitcnt vmcnt(14) lgkmcnt(4)
v_mfma_f32_32x32x16_bf16 v[184:199], v[112:115], v[40:43], v[184:199]
ds_read_b64_tr_b16 v[96:97], v8 offset:8192
ds_read_b64_tr_b16 v[98:99], v8 offset:8704
ds_read_b64_tr_b16 v[100:101], v11 offset:8192
ds_read_b64_tr_b16 v[102:103], v11 offset:8704
v_mfma_f32_32x32x16_bf16 v[200:215], v[116:119], v[40:43], v[200:215]
buffer_load_dwordx4 v[36:39], v25, s[32:35], s51 offen offset:3072 sc1
s_waitcnt vmcnt(14) lgkmcnt(4)
s_barrier
v_mfma_f32_32x32x16_bf16 v[184:199], v[120:123], v[44:47], v[184:199]
ds_read_b64_tr_b16 v[104:105], v8 offset:10240
ds_read_b64_tr_b16 v[106:107], v8 offset:10752
ds_read_b64_tr_b16 v[108:109], v11 offset:10240
ds_read_b64_tr_b16 v[110:111], v11 offset:10752
v_mfma_f32_32x32x16_bf16 v[200:215], v[124:127], v[44:47], v[200:215]
s_add_u32 s51, s61, 8192
buffer_load_dwordx4 v[40:43], v25, s[32:35], s51 offen offset:0 sc1
s_waitcnt vmcnt(14) lgkmcnt(4)
v_mfma_f32_32x32x16_bf16 v[184:199], v[96:99], v[48:51], v[184:199]
ds_read_b64_tr_b16 v[112:113], v8 offset:12288
ds_read_b64_tr_b16 v[114:115], v8 offset:12800
ds_read_b64_tr_b16 v[116:117], v11 offset:12288
ds_read_b64_tr_b16 v[118:119], v11 offset:12800
v_mfma_f32_32x32x16_bf16 v[200:215], v[100:103], v[48:51], v[200:215]
buffer_load_dwordx4 v[44:47], v25, s[32:35], s51 offen offset:1024 sc1
s_waitcnt vmcnt(14) lgkmcnt(4)
v_mfma_f32_32x32x16_bf16 v[184:199], v[104:107], v[52:55], v[184:199]
ds_read_b64_tr_b16 v[120:121], v8 offset:14336
ds_read_b64_tr_b16 v[122:123], v8 offset:14848
ds_read_b64_tr_b16 v[124:125], v11 offset:14336
ds_read_b64_tr_b16 v[126:127], v11 offset:14848
v_mfma_f32_32x32x16_bf16 v[200:215], v[108:111], v[52:55], v[200:215]
s_add_u32 s51, s62, 0
buffer_load_dwordx4 v[48:51], v25, s[32:35], s51 offen offset:0 sc1
s_waitcnt vmcnt(14) lgkmcnt(4)
v_mfma_f32_32x32x16_bf16 v[184:199], v[112:115], v[56:59], v[184:199]
ds_read_b64_tr_b16 v[96:97], v8 offset:16384
ds_read_b64_tr_b16 v[98:99], v8 offset:16896
ds_read_b64_tr_b16 v[100:101], v11 offset:16384
ds_read_b64_tr_b16 v[102:103], v11 offset:16896
v_mfma_f32_32x32x16_bf16 v[200:215], v[116:119], v[56:59], v[200:215]
buffer_load_dwordx4 v[52:55], v25, s[32:35], s51 offen offset:1024 sc1
s_waitcnt vmcnt(14) lgkmcnt(4)
v_mfma_f32_32x32x16_bf16 v[184:199], v[120:123], v[60:63], v[184:199]
ds_read_b64_tr_b16 v[104:105], v8 offset:18432
ds_read_b64_tr_b16 v[106:107], v8 offset:18944
ds_read_b64_tr_b16 v[108:109], v11 offset:18432
ds_read_b64_tr_b16 v[110:111], v11 offset:18944
v_mfma_f32_32x32x16_bf16 v[200:215], v[124:127], v[60:63], v[200:215]
buffer_load_dwordx4 v[56:59], v25, s[32:35], s51 offen offset:2048 sc1
s_waitcnt vmcnt(14) lgkmcnt(4)
v_mfma_f32_32x32x16_bf16 v[184:199], v[96:99], v[64:67], v[184:199]
ds_read_b64_tr_b16 v[112:113], v8 offset:40960
ds_read_b64_tr_b16 v[114:115], v8 offset:41472
ds_read_b64_tr_b16 v[116:117], v11 offset:40960
ds_read_b64_tr_b16 v[118:119], v11 offset:41472
v_mfma_f32_32x32x16_bf16 v[200:215], v[100:103], v[64:67], v[200:215]
buffer_load_dwordx4 v[60:63], v25, s[32:35], s51 offen offset:3072 sc1
s_waitcnt vmcnt(14) lgkmcnt(4)
v_mfma_f32_32x32x16_bf16 v[184:199], v[104:107], v[68:71], v[184:199]
ds_read_b64_tr_b16 v[120:121], v8 offset:43008
ds_read_b64_tr_b16 v[122:123], v8 offset:43520
ds_read_b64_tr_b16 v[124:125], v11 offset:43008
ds_read_b64_tr_b16 v[126:127], v11 offset:43520
v_mfma_f32_32x32x16_bf16 v[200:215], v[108:111], v[68:71], v[200:215]
s_add_u32 s51, s62, 4096
buffer_load_dwordx4 v[64:67], v25, s[32:35], s51 offen offset:0 sc1
s_waitcnt vmcnt(14) lgkmcnt(4)
v_mfma_f32_32x32x16_bf16 v[184:199], v[112:115], v[72:75], v[184:199]
ds_read_b64_tr_b16 v[96:97], v8 offset:45056
ds_read_b64_tr_b16 v[98:99], v8 offset:45568
ds_read_b64_tr_b16 v[100:101], v11 offset:45056
ds_read_b64_tr_b16 v[102:103], v11 offset:45568
v_mfma_f32_32x32x16_bf16 v[200:215], v[116:119], v[72:75], v[200:215]
buffer_load_dwordx4 v[68:71], v25, s[32:35], s51 offen offset:1024 sc1
s_waitcnt vmcnt(14) lgkmcnt(4)
v_mfma_f32_32x32x16_bf16 v[184:199], v[120:123], v[76:79], v[184:199]
ds_read_b64_tr_b16 v[104:105], v8 offset:47104
ds_read_b64_tr_b16 v[106:107], v8 offset:47616
ds_read_b64_tr_b16 v[108:109], v11 offset:47104
ds_read_b64_tr_b16 v[110:111], v11 offset:47616
v_mfma_f32_32x32x16_bf16 v[200:215], v[124:127], v[76:79], v[200:215]
buffer_load_dwordx4 v[72:75], v25, s[32:35], s51 offen offset:2048 sc1
s_waitcnt vmcnt(14) lgkmcnt(4)
v_mfma_f32_32x32x16_bf16 v[184:199], v[96:99], v[80:83], v[184:199]
ds_read_b64_tr_b16 v[112:113], v8 offset:49152
ds_read_b64_tr_b16 v[114:115], v8 offset:49664
ds_read_b64_tr_b16 v[116:117], v11 offset:49152
ds_read_b64_tr_b16 v[118:119], v11 offset:49664
v_mfma_f32_32x32x16_bf16 v[200:215], v[100:103], v[80:83], v[200:215]
buffer_load_dwordx4 v[76:79], v25, s[32:35], s51 offen offset:3072 sc1
s_waitcnt vmcnt(14) lgkmcnt(4)
v_mfma_f32_32x32x16_bf16 v[184:199], v[104:107], v[84:87], v[184:199]
ds_read_b64_tr_b16 v[120:121], v8 offset:51200
ds_read_b64_tr_b16 v[122:123], v8 offset:51712
ds_read_b64_tr_b16 v[124:125], v11 offset:51200
ds_read_b64_tr_b16 v[126:127], v11 offset:51712
v_mfma_f32_32x32x16_bf16 v[200:215], v[108:111], v[84:87], v[200:215]
s_add_u32 s51, s62, 8192
buffer_load_dwordx4 v[80:83], v25, s[32:35], s51 offen offset:0 sc1
s_waitcnt vmcnt(14) lgkmcnt(4)
v_mfma_f32_32x32x16_bf16 v[184:199], v[112:115], v[88:91], v[184:199]
ds_read_b64_tr_b16 v[96:97], v8 offset:53248
ds_read_b64_tr_b16 v[98:99], v8 offset:53760
ds_read_b64_tr_b16 v[100:101], v11 offset:53248
ds_read_b64_tr_b16 v[102:103], v11 offset:53760
v_mfma_f32_32x32x16_bf16 v[200:215], v[116:119], v[88:91], v[200:215]
buffer_load_dwordx4 v[84:87], v25, s[32:35], s51 offen offset:1024 sc1
s_waitcnt vmcnt(14) lgkmcnt(4)
v_mfma_f32_32x32x16_bf16 v[184:199], v[120:123], v[92:95], v[184:199]
ds_read_b64_tr_b16 v[104:105], v8 offset:55296
ds_read_b64_tr_b16 v[106:107], v8 offset:55808
ds_read_b64_tr_b16 v[108:109], v11 offset:55296
ds_read_b64_tr_b16 v[110:111], v11 offset:55808
v_mfma_f32_32x32x16_bf16 v[200:215], v[124:127], v[92:95], v[200:215]
s_add_u32 s51, s63, 0
buffer_load_dwordx4 v[88:91], v25, s[32:35], s51 offen offset:0 sc1
s_waitcnt vmcnt(14) lgkmcnt(4)
v_mfma_f32_32x32x16_bf16 v[184:199], v[96:99], v[32:35], v[184:199]
ds_read_b64_tr_b16 v[112:113], v8 offset:57344
ds_read_b64_tr_b16 v[114:115], v8 offset:57856
ds_read_b64_tr_b16 v[116:117], v11 offset:57344
ds_read_b64_tr_b16 v[118:119], v11 offset:57856
v_mfma_f32_32x32x16_bf16 v[200:215], v[100:103], v[32:35], v[200:215]
buffer_load_dwordx4 v[92:95], v25, s[32:35], s51 offen offset:1024 sc1
s_waitcnt vmcnt(14) lgkmcnt(4)
v_mfma_f32_32x32x16_bf16 v[184:199], v[104:107], v[36:39], v[184:199]
ds_read_b64_tr_b16 v[120:121], v8 offset:59392
ds_read_b64_tr_b16 v[122:123], v8 offset:59904
ds_read_b64_tr_b16 v[124:125], v11 offset:59392
ds_read_b64_tr_b16 v[126:127], v11 offset:59904
v_mfma_f32_32x32x16_bf16 v[200:215], v[108:111], v[36:39], v[200:215]
buffer_load_dwordx4 v[32:35], v25, s[32:35], s51 offen offset:2048 sc1
s_waitcnt vmcnt(14) lgkmcnt(4)
v_mfma_f32_32x32x16_bf16 v[184:199], v[112:115], v[40:43], v[184:199]
ds_read_b64_tr_b16 v[96:97], v9 offset:20480
ds_read_b64_tr_b16 v[98:99], v9 offset:20992
ds_read_b64_tr_b16 v[100:101], v12 offset:20480
ds_read_b64_tr_b16 v[102:103], v12 offset:20992
v_mfma_f32_32x32x16_bf16 v[200:215], v[116:119], v[40:43], v[200:215]
buffer_load_dwordx4 v[36:39], v25, s[32:35], s51 offen offset:3072 sc1
s_waitcnt vmcnt(14) lgkmcnt(4)
v_mfma_f32_32x32x16_bf16 v[184:199], v[120:123], v[44:47], v[184:199]
ds_read_b64_tr_b16 v[104:105], v9 offset:22528
ds_read_b64_tr_b16 v[106:107], v9 offset:23040
ds_read_b64_tr_b16 v[108:109], v12 offset:22528
ds_read_b64_tr_b16 v[110:111], v12 offset:23040
v_mfma_f32_32x32x16_bf16 v[200:215], v[124:127], v[44:47], v[200:215]
s_add_u32 s51, s63, 4096
buffer_load_dwordx4 v[40:43], v25, s[32:35], s51 offen offset:0 sc1
s_waitcnt vmcnt(14) lgkmcnt(4)
v_mfma_f32_32x32x16_bf16 v[184:199], v[96:99], v[48:51], v[184:199]
ds_read_b64_tr_b16 v[112:113], v9 offset:24576
ds_read_b64_tr_b16 v[114:115], v9 offset:25088
ds_read_b64_tr_b16 v[116:117], v12 offset:24576
ds_read_b64_tr_b16 v[118:119], v12 offset:25088
v_mfma_f32_32x32x16_bf16 v[200:215], v[100:103], v[48:51], v[200:215]
buffer_load_dwordx4 v[44:47], v25, s[32:35], s51 offen offset:1024 sc1
s_waitcnt vmcnt(14) lgkmcnt(4)
v_mfma_f32_32x32x16_bf16 v[184:199], v[104:107], v[52:55], v[184:199]
ds_read_b64_tr_b16 v[120:121], v9 offset:26624
ds_read_b64_tr_b16 v[122:123], v9 offset:27136
ds_read_b64_tr_b16 v[124:125], v12 offset:26624
ds_read_b64_tr_b16 v[126:127], v12 offset:27136
v_mfma_f32_32x32x16_bf16 v[200:215], v[108:111], v[52:55], v[200:215]
buffer_load_dwordx4 v[48:51], v25, s[32:35], s51 offen offset:2048 sc1
s_waitcnt vmcnt(14) lgkmcnt(4)
v_mfma_f32_32x32x16_bf16 v[184:199], v[112:115], v[56:59], v[184:199]
ds_read_b64_tr_b16 v[96:97], v9 offset:28672
ds_read_b64_tr_b16 v[98:99], v9 offset:29184
ds_read_b64_tr_b16 v[100:101], v12 offset:28672
ds_read_b64_tr_b16 v[102:103], v12 offset:29184
v_mfma_f32_32x32x16_bf16 v[200:215], v[116:119], v[56:59], v[200:215]
buffer_load_dwordx4 v[52:55], v25, s[32:35], s51 offen offset:3072 sc1
s_waitcnt vmcnt(14) lgkmcnt(4)
v_mfma_f32_32x32x16_bf16 v[184:199], v[120:123], v[60:63], v[184:199]
ds_read_b64_tr_b16 v[104:105], v9 offset:30720
ds_read_b64_tr_b16 v[106:107], v9 offset:31232
ds_read_b64_tr_b16 v[108:109], v12 offset:30720
ds_read_b64_tr_b16 v[110:111], v12 offset:31232
v_mfma_f32_32x32x16_bf16 v[200:215], v[124:127], v[60:63], v[200:215]
s_add_u32 s51, s63, 8192
buffer_load_dwordx4 v[56:59], v25, s[32:35], s51 offen offset:0 sc1
s_waitcnt vmcnt(14) lgkmcnt(4)
v_mfma_f32_32x32x16_bf16 v[184:199], v[96:99], v[64:67], v[184:199]
ds_read_b64_tr_b16 v[112:113], v9 offset:32768
ds_read_b64_tr_b16 v[114:115], v9 offset:33280
ds_read_b64_tr_b16 v[116:117], v12 offset:32768
ds_read_b64_tr_b16 v[118:119], v12 offset:33280
v_mfma_f32_32x32x16_bf16 v[200:215], v[100:103], v[64:67], v[200:215]
buffer_load_dwordx4 v[60:63], v25, s[32:35], s51 offen offset:1024 sc1
s_waitcnt vmcnt(14) lgkmcnt(4)
v_mfma_f32_32x32x16_bf16 v[184:199], v[104:107], v[68:71], v[184:199]
ds_read_b64_tr_b16 v[120:121], v9 offset:34816
ds_read_b64_tr_b16 v[122:123], v9 offset:35328
ds_read_b64_tr_b16 v[124:125], v12 offset:34816
ds_read_b64_tr_b16 v[126:127], v12 offset:35328
v_mfma_f32_32x32x16_bf16 v[200:215], v[108:111], v[68:71], v[200:215]
s_add_u32 s51, s72, 40960
buffer_load_dwordx4 v[64:67], v25, s[32:35], s51 offen offset:0 sc1
s_waitcnt vmcnt(14) lgkmcnt(4)
v_mfma_f32_32x32x16_bf16 v[184:199], v[112:115], v[72:75], v[184:199]
ds_read_b64_tr_b16 v[96:97], v9 offset:36864
ds_read_b64_tr_b16 v[98:99], v9 offset:37376
ds_read_b64_tr_b16 v[100:101], v12 offset:36864
ds_read_b64_tr_b16 v[102:103], v12 offset:37376
v_mfma_f32_32x32x16_bf16 v[200:215], v[116:119], v[72:75], v[200:215]
buffer_load_dwordx4 v[68:71], v25, s[32:35], s51 offen offset:1024 sc1
s_waitcnt vmcnt(14) lgkmcnt(4)
v_mfma_f32_32x32x16_bf16 v[184:199], v[120:123], v[76:79], v[184:199]
ds_read_b64_tr_b16 v[104:105], v9 offset:38912
ds_read_b64_tr_b16 v[106:107], v9 offset:39424
ds_read_b64_tr_b16 v[108:109], v12 offset:38912
ds_read_b64_tr_b16 v[110:111], v12 offset:39424
v_mfma_f32_32x32x16_bf16 v[200:215], v[124:127], v[76:79], v[200:215]
buffer_load_dwordx4 v[72:75], v25, s[32:35], s51 offen offset:2048 sc1
s_waitcnt vmcnt(14) lgkmcnt(4)
v_mfma_f32_32x32x16_bf16 v[184:199], v[96:99], v[80:83], v[184:199]
ds_read_b64_tr_b16 v[112:113], v10 offset:0
ds_read_b64_tr_b16 v[114:115], v10 offset:512
ds_read_b64_tr_b16 v[116:117], v13 offset:0
ds_read_b64_tr_b16 v[118:119], v13 offset:512
v_mfma_f32_32x32x16_bf16 v[200:215], v[100:103], v[80:83], v[200:215]
s_waitcnt vmcnt(13) lgkmcnt(4)
v_mfma_f32_32x32x16_bf16 v[184:199], v[104:107], v[84:87], v[184:199]
ds_read_b64_tr_b16 v[120:121], v10 offset:2048
ds_read_b64_tr_b16 v[122:123], v10 offset:2560
ds_read_b64_tr_b16 v[124:125], v13 offset:2048
ds_read_b64_tr_b16 v[126:127], v13 offset:2560
v_mfma_f32_32x32x16_bf16 v[200:215], v[108:111], v[84:87], v[200:215]
s_waitcnt vmcnt(12) lgkmcnt(4)
v_mfma_f32_32x32x16_bf16 v[184:199], v[112:115], v[88:91], v[184:199]
ds_read_b64_tr_b16 v[96:97], v10 offset:4096
ds_read_b64_tr_b16 v[98:99], v10 offset:4608
ds_read_b64_tr_b16 v[100:101], v13 offset:4096
ds_read_b64_tr_b16 v[102:103], v13 offset:4608
v_mfma_f32_32x32x16_bf16 v[200:215], v[116:119], v[88:91], v[200:215]
s_waitcnt vmcnt(11) lgkmcnt(4)
v_mfma_f32_32x32x16_bf16 v[184:199], v[120:123], v[92:95], v[184:199]
ds_read_b64_tr_b16 v[104:105], v10 offset:6144
ds_read_b64_tr_b16 v[106:107], v10 offset:6656
ds_read_b64_tr_b16 v[108:109], v13 offset:6144
ds_read_b64_tr_b16 v[110:111], v13 offset:6656
v_mfma_f32_32x32x16_bf16 v[200:215], v[124:127], v[92:95], v[200:215]
s_waitcnt vmcnt(10) lgkmcnt(4)
v_mfma_f32_32x32x16_bf16 v[184:199], v[96:99], v[32:35], v[184:199]
ds_read_b64_tr_b16 v[112:113], v10 offset:8192
ds_read_b64_tr_b16 v[114:115], v10 offset:8704
ds_read_b64_tr_b16 v[116:117], v13 offset:8192
ds_read_b64_tr_b16 v[118:119], v13 offset:8704
v_mfma_f32_32x32x16_bf16 v[200:215], v[100:103], v[32:35], v[200:215]
s_waitcnt vmcnt(9) lgkmcnt(4)
v_mfma_f32_32x32x16_bf16 v[184:199], v[104:107], v[36:39], v[184:199]
ds_read_b64_tr_b16 v[120:121], v10 offset:10240
ds_read_b64_tr_b16 v[122:123], v10 offset:10752
ds_read_b64_tr_b16 v[124:125], v13 offset:10240
ds_read_b64_tr_b16 v[126:127], v13 offset:10752
v_mfma_f32_32x32x16_bf16 v[200:215], v[108:111], v[36:39], v[200:215]
s_waitcnt vmcnt(8) lgkmcnt(4)
v_mfma_f32_32x32x16_bf16 v[184:199], v[112:115], v[40:43], v[184:199]
ds_read_b64_tr_b16 v[96:97], v10 offset:12288
ds_read_b64_tr_b16 v[98:99], v10 offset:12800
ds_read_b64_tr_b16 v[100:101], v13 offset:12288
ds_read_b64_tr_b16 v[102:103], v13 offset:12800
v_mfma_f32_32x32x16_bf16 v[200:215], v[116:119], v[40:43], v[200:215]
s_waitcnt vmcnt(7) lgkmcnt(4)
v_mfma_f32_32x32x16_bf16 v[184:199], v[120:123], v[44:47], v[184:199]
ds_read_b64_tr_b16 v[104:105], v10 offset:14336
ds_read_b64_tr_b16 v[106:107], v10 offset:14848
ds_read_b64_tr_b16 v[108:109], v13 offset:14336
ds_read_b64_tr_b16 v[110:111], v13 offset:14848
v_mfma_f32_32x32x16_bf16 v[200:215], v[124:127], v[44:47], v[200:215]
s_waitcnt vmcnt(6) lgkmcnt(4)
v_mfma_f32_32x32x16_bf16 v[184:199], v[96:99], v[48:51], v[184:199]
ds_read_b64_tr_b16 v[112:113], v10 offset:16384
ds_read_b64_tr_b16 v[114:115], v10 offset:16896
ds_read_b64_tr_b16 v[116:117], v13 offset:16384
ds_read_b64_tr_b16 v[118:119], v13 offset:16896
v_mfma_f32_32x32x16_bf16 v[200:215], v[100:103], v[48:51], v[200:215]
s_waitcnt vmcnt(5) lgkmcnt(4)
v_mfma_f32_32x32x16_bf16 v[184:199], v[104:107], v[52:55], v[184:199]
ds_read_b64_tr_b16 v[120:121], v10 offset:18432
ds_read_b64_tr_b16 v[122:123], v10 offset:18944
ds_read_b64_tr_b16 v[124:125], v13 offset:18432
ds_read_b64_tr_b16 v[126:127], v13 offset:18944
v_mfma_f32_32x32x16_bf16 v[200:215], v[108:111], v[52:55], v[200:215]
s_waitcnt vmcnt(4) lgkmcnt(4)
s_barrier
v_mfma_f32_32x32x16_bf16 v[184:199], v[112:115], v[56:59], v[184:199]
ds_read_b64_tr_b16 v[96:97], v8 offset:0
ds_read_b64_tr_b16 v[98:99], v8 offset:512
ds_read_b64_tr_b16 v[100:101], v11 offset:0
ds_read_b64_tr_b16 v[102:103], v11 offset:512
v_mfma_f32_32x32x16_bf16 v[200:215], v[116:119], v[56:59], v[200:215]
s_waitcnt vmcnt(3) lgkmcnt(4)
v_mfma_f32_32x32x16_bf16 v[184:199], v[120:123], v[60:63], v[184:199]
ds_read_b64_tr_b16 v[104:105], v8 offset:2048
ds_read_b64_tr_b16 v[106:107], v8 offset:2560
ds_read_b64_tr_b16 v[108:109], v11 offset:2048
ds_read_b64_tr_b16 v[110:111], v11 offset:2560
v_mfma_f32_32x32x16_bf16 v[200:215], v[124:127], v[60:63], v[200:215]
s_waitcnt vmcnt(2) lgkmcnt(4)
v_mfma_f32_32x32x16_bf16 v[184:199], v[96:99], v[64:67], v[184:199]
ds_read_b64_tr_b16 v[112:113], v8 offset:4096
ds_read_b64_tr_b16 v[114:115], v8 offset:4608
ds_read_b64_tr_b16 v[116:117], v11 offset:4096
ds_read_b64_tr_b16 v[118:119], v11 offset:4608
v_mfma_f32_32x32x16_bf16 v[200:215], v[100:103], v[64:67], v[200:215]
s_waitcnt vmcnt(1) lgkmcnt(4)
v_mfma_f32_32x32x16_bf16 v[184:199], v[104:107], v[68:71], v[184:199]
v_mfma_f32_32x32x16_bf16 v[200:215], v[108:111], v[68:71], v[200:215]
s_waitcnt vmcnt(0) lgkmcnt(0)
v_mfma_f32_32x32x16_bf16 v[184:199], v[112:115], v[72:75], v[184:199]
v_mfma_f32_32x32x16_bf16 v[200:215], v[116:119], v[72:75], v[200:215]
s_cmp_eq_u32 s66, 0
s_nop 7
s_nop 1
s_cbranch_scc1 P2_KH0
ds_write_b128 v6, v[184:187] offset:0
ds_write_b128 v6, v[188:191] offset:1024
ds_write_b128 v6, v[192:195] offset:2048
ds_write_b128 v6, v[196:199] offset:3072
s_waitcnt lgkmcnt(0)
s_barrier
ds_read_b128 v[216:219], v7 offset:0
ds_read_b128 v[220:223], v7 offset:1024
ds_read_b128 v[224:227], v7 offset:2048
ds_read_b128 v[228:231], v7 offset:3072
s_waitcnt lgkmcnt(3)
v_pk_add_f32 v[216:217], v[216:217], v[200:201]
v_pk_add_f32 v[218:219], v[218:219], v[202:203]
v_cvt_pk_bf16_f32 v32, v216, v217
v_cvt_pk_bf16_f32 v33, v218, v219
s_waitcnt lgkmcnt(2)
v_pk_add_f32 v[220:221], v[220:221], v[204:205]
v_pk_add_f32 v[222:223], v[222:223], v[206:207]
v_cvt_pk_bf16_f32 v34, v220, v221
v_cvt_pk_bf16_f32 v35, v222, v223
buffer_store_dwordx4 v[32:35], v14, s[40:43], 0 offen
s_waitcnt lgkmcnt(1)
v_pk_add_f32 v[224:225], v[224:225], v[208:209]
v_pk_add_f32 v[226:227], v[226:227], v[210:211]
v_cvt_pk_bf16_f32 v36, v224, v225
v_cvt_pk_bf16_f32 v37, v226, v227
s_waitcnt lgkmcnt(0)
v_pk_add_f32 v[228:229], v[228:229], v[212:213]
v_pk_add_f32 v[230:231], v[230:231], v[214:215]
v_cvt_pk_bf16_f32 v38, v228, v229
v_cvt_pk_bf16_f32 v39, v230, v231
buffer_store_dwordx4 v[36:39], v14, s[40:43], 0 offen offset:16
s_endpgm
P2_KH0:
ds_write_b128 v6, v[200:203] offset:0
ds_write_b128 v6, v[204:207] offset:1024
ds_write_b128 v6, v[208:211] offset:2048
ds_write_b128 v6, v[212:215] offset:3072
s_waitcnt lgkmcnt(0)
s_barrier
ds_read_b128 v[216:219], v7 offset:0
ds_read_b128 v[220:223], v7 offset:1024
ds_read_b128 v[224:227], v7 offset:2048
ds_read_b128 v[228:231], v7 offset:3072
s_waitcnt lgkmcnt(3)
v_pk_add_f32 v[216:217], v[216:217], v[184:185]
v_pk_add_f32 v[218:219], v[218:219], v[186:187]
v_cvt_pk_bf16_f32 v32, v216, v217
v_cvt_pk_bf16_f32 v33, v218, v219
s_waitcnt lgkmcnt(2)
v_pk_add_f32 v[220:221], v[220:221], v[188:189]
v_pk_add_f32 v[222:223], v[222:223], v[190:191]
v_cvt_pk_bf16_f32 v34, v220, v221
v_cvt_pk_bf16_f32 v35, v222, v223
buffer_store_dwordx4 v[32:35], v14, s[40:43], 0 offen
s_waitcnt lgkmcnt(1)
v_pk_add_f32 v[224:225], v[224:225], v[192:193]
v_pk_add_f32 v[226:227], v[226:227], v[194:195]
v_cvt_pk_bf16_f32 v36, v224, v225
v_cvt_pk_bf16_f32 v37, v226, v227
s_waitcnt lgkmcnt(0)
v_pk_add_f32 v[228:229], v[228:229], v[196:197]
v_pk_add_f32 v[230:231], v[230:231], v[198:199]
v_cvt_pk_bf16_f32 v38, v228, v229
v_cvt_pk_bf16_f32 v39, v230, v231
buffer_store_dwordx4 v[36:39], v14, s[40:43], 0 offen offset:16
s_endpgm
KEND:
.section .rodata,"a"
.p2align 6
.amdhsa_kernel standalone__glu_gated_geglu__prompt_kernel
  .amdhsa_next_free_vgpr 256
  .amdhsa_next_free_sgpr 102
  .amdhsa_accum_offset 256
  .amdhsa_group_segment_fixed_size 0
  .amdhsa_kernarg_size 56
  .amdhsa_user_sgpr_count 2
  .amdhsa_user_sgpr_kernarg_segment_ptr 1
  .amdhsa_system_sgpr_workgroup_id_x 1
  .amdhsa_float_denorm_mode_32 3
.end_amdhsa_kernel
```
